```python
import torch

def _softmax(x, axis=-1):
    return torch.softmax(x, dim=axis)
def _gelu(x):
    return torch.nn.functional.gelu(x, approximate="tanh")
def _silu(x):
    return torch.nn.functional.silu(x)
def _sigmoid(x):
    return torch.sigmoid(x)
def _layernorm(x, axis=-1, eps=1e-5):
    m = x.mean(dim=axis, keepdim=True)
    v = x.var(dim=axis, keepdim=True, unbiased=False)
    return (x - m) / torch.sqrt(v + eps)
def _scatter_add(tgt, idx, src, axis=0):
    return tgt.clone().index_add_(axis, idx, src)
def _segment_sum(src, seg, n):
    out = torch.zeros((n,) + src.shape[1:], dtype=src.dtype)
    return out.index_add_(0, seg, src)
def _pad(x, pw):
    flat = tuple(v for pair in reversed(pw) for v in pair)
    return torch.nn.functional.pad(x, flat)

kernel_name = 'gated_mix__mha_block__dense_activation_squared_relu__prompt'

def setup_inputs():

    _w = (lambda a: (lambda t: t.to(torch.bfloat16) if t.is_floating_point() else t)(torch.as_tensor(a)))
    def _A_setup():
        B, S, D, H = 1, 2048, 512, 32
        return {
            "x": _w((lambda *s: torch.randn(*s, dtype=torch.bfloat16) * 0.05)(B, S, D)),
            "wqkv": _w((lambda *s: torch.randn(*s, dtype=torch.bfloat16) * 0.8)(D, 3 * D)),
            "wo": _w((lambda *s: torch.randn(*s, dtype=torch.bfloat16) * 0.1)(D, D)),
        }
    _A_in = _A_setup()

    def _B_setup():
        B, S, D, F = 1, 2048, 512, 1792
        return {
            "x": _w((lambda *s: torch.randn(*s, dtype=torch.bfloat16) * 0.05)(B, S, D)),
            "w1": _w((lambda *s: torch.randn(*s, dtype=torch.bfloat16) * 0.1)(D, F)),
            "b1": _w((lambda *s: torch.randn(*s, dtype=torch.bfloat16) * 0.05)(F)),
            "w2": _w((lambda *s: torch.randn(*s, dtype=torch.bfloat16) * 0.05)(F, D)),
            "b2": _w((lambda *s: torch.randn(*s, dtype=torch.bfloat16) * 0.05)(D)),
        }
    _B_in = _B_setup()

    return {
        "A_x": _A_in["x"],
        "A_wqkv": _A_in["wqkv"],
        "A_wo": _A_in["wo"],
        "B_x": _B_in["x"],
        "B_w1": _B_in["w1"],
        "B_b1": _B_in["b1"],
        "B_w2": _B_in["w2"],
        "B_b2": _B_in["b2"],
        "gate_w": _w((lambda *s: torch.randn(*s, dtype=torch.bfloat16) * 0.05)(512) * 16.0),
    }

def reference(A_x, A_wqkv, A_wo, B_x, B_w1, B_b1, B_w2, B_b2, gate_w):
    def _A_ref(x, wqkv, wo):
        B, S, D = x.shape
        H = 32
        Dh = D // H
        qkv = (lambda x, *d: x.permute(*d))((x @ wqkv).reshape(B, S, 3, H, Dh), 2, 0, 3, 1, 4)
        q, k, v = qkv[0], qkv[1], qkv[2]
        scores = torch.einsum("bhqd,bhkd->bhqk", q, k) * (Dh ** -0.5)
        p = _softmax(scores, axis=-1)
        o = torch.einsum("bhqk,bhkd->bhqd", p, v)
        return (lambda x, *d: x.permute(*d))(o, 0, 2, 1, 3).reshape(B, S, D) @ wo

    def _B_ref(x, w1, b1, w2, b2):
        h = torch.einsum("bsd,df->bsf", x, w1) + b1
        zero = torch.zeros_like(h)
        r = torch.where(h > zero, h, zero)
        h = r * r
        out = torch.einsum("bsf,fd->bsd", h, w2) + b2
        return out

    x = A_x
    g = _sigmoid((x * gate_w).sum(-1, keepdims=True))
    a = _A_ref(x, A_wqkv, A_wo)
    b = _B_ref(x, B_w1, B_b1, B_w2, B_b2)
    return g * a + (1 - g) * b
```

```asm
; @launch grid=(256,1,1) block=(768,1,1) lds=163840
.amdgcn_target "amdgcn-amd-amdhsa--gfx950"
.text
.globl gated_mix__mha_block__dense_activation_squared_relu__prompt_kernel
.p2align 8
.type gated_mix__mha_block__dense_activation_squared_relu__prompt_kernel,@function
gated_mix__mha_block__dense_activation_squared_relu__prompt_kernel:
    s_cmp_ge_u32 s2, 256
    s_cbranch_scc1 k_end
    s_memrealtime s[100:101]
    s_load_dwordx16 s[16:31], s[0:1], 0
    s_load_dwordx8 s[32:39], s[0:1], 64
    v_lshrrev_b32 v1, 6, v0
    v_and_b32 v0, 63, v0
    v_readfirstlane_b32 s3, v1
    v_lshlrev_b32 v2, 4, v0
    s_and_b32 s56, s2, 7
    s_lshr_b32 s57, s2, 3
    s_and_b32 s86, s57, 3
    s_lshr_b32 s87, s57, 2
    s_lshl2_add_u32 s88, s56, s86
    s_add_u32 s11, s87, s56
    s_and_b32 s11, s11, 7
    s_mul_i32 s4, s11, 0x11111111
    s_add_u32 s58, s4, 0x76543210
    s_and_b32 s89, s88, 7
    s_min_u32 s4, s89, 6
    s_lshr_b32 s5, s56, 1
    s_mul_i32 s5, s5, 7
    s_add_u32 s4, s4, s5
    s_lshl_b32 s91, s4, 7
    s_and_b32 s84, s3, 3
    s_cmp_ge_u32 s3, 4
    s_cbranch_scc1 a_p1
    s_setprio 3
    v_lshrrev_b32 v9, 3, v0
    v_lshrrev_b32 v11, 4, v0
    v_xor_b32 v12, v11, v0
    v_and_b32 v12, 7, v12
    v_lshlrev_b32 v12, 4, v12
    v_lshl_add_u32 v32, v9, 10, v12
    s_lshl_b32 s8, s87, 18
    v_xor_b32 v33, 64, v32
    v_add_u32 v33, 7168, v33
    s_mul_i32 s9, s84, 49152
    s_lshl_b32 s12, s88, 5
    s_add_u32 s9, s9, s12
    s_mul_i32 s10, s3, 57344
    s_add_u32 s10, s10, s91
    s_lshl_b32 s14, s3, 13
    s_lshl_b32 s15, s84, 11
    s_lshl_b32 s63, s86, 11
    s_or_b32 s4, s63, s14
    s_add_u32 s5, s63, 2048
    s_and_b32 s5, s5, 0x1800
    s_or_b32 s5, s5, s14
    s_add_u32 s6, s63, 4096
    s_and_b32 s6, s6, 0x1800
    s_or_b32 s6, s6, s14
    s_add_u32 s7, s63, 6144
    s_and_b32 s7, s7, 0x1800
    s_or_b32 s7, s7, s14
    s_and_b32 s61, s86, 1
    s_lshl_b32 s59, s61, 10
    s_add_u32 s59, s59, s15
    s_xor_b32 s60, s59, 1024
    s_mul_i32 s61, s61, 24576
    s_sub_u32 s62, 24576, s61
    v_lshlrev_b32 v11, 2, v11
    v_xor_b32 v11, v11, v0
    v_and_b32 v11, 7, v11
    v_mul_u32_u24 v36, 3584, v9
    v_lshl_add_u32 v36, v11, 4, v36
    v_add_u32 v37, 27648, v36
    s_cmp_eq_u32 s89, 7
    s_cselect_b32 s63, 0, -1
    v_and_b32 v36, s63, v36
    v_and_b32 v37, s63, v37
    s_and_b32 s63, s86, 1
    v_lshrrev_b32 v12, 1, v11
    v_xor_b32 v12, s63, v12
    v_xor_b32 v13, 1, v12
    v_min_u32 v12, 2, v12
    v_min_u32 v13, 2, v13
    v_mul_u32_u24 v104, 3072, v9
    v_and_b32 v10, 1, v11
    v_lshl_add_u32 v104, v10, 4, v104
    v_lshl_add_u32 v105, v13, 10, v104
    v_lshl_add_u32 v104, v12, 10, v104
    v_add_u32 v105, s62, v105
    v_add_u32 v104, s61, v104
    s_mov_b32 s46, 0x200000
    s_mov_b32 s47, 0x00020000
    s_mov_b32 s50, 0x180000
    s_mov_b32 s51, 0x00020000
    s_mov_b32 s54, 0x1c0000
    s_mov_b32 s55, 0x00020000
    s_lshl_b32 s13, s11, 7
    s_add_u32 s13, s13, s8
    s_mul_i32 s82, s11, 196608
    s_add_u32 s82, s82, s9
    s_mul_i32 s83, s11, 229376
    s_add_u32 s83, s83, s10
    s_add_u32 m0, s15, 90112
    s_waitcnt lgkmcnt(0)
    s_mov_b32 s48, s18
    s_and_b32 s49, s19, 0xffff
    buffer_load_dwordx4 v[96:99], v104, s[48:51], s82 offen
    buffer_load_dwordx4 v[100:103], v105, s[48:51], s82 offen
    s_mov_b32 s52, s24
    s_and_b32 s53, s25, 0xffff
    buffer_load_dwordx4 v36, s[52:55], s83 offen offset:0 lds
    buffer_load_dwordx4 v37, s[52:55], s83 offen offset:1024 lds
    s_mov_b32 s44, s16
    s_and_b32 s45, s17, 0xffff
    s_add_u32 m0, s4, 49152
    s_lshl3_add_u32 s12, s4, s13
    buffer_load_dwordx4 v32, s[44:47], s12 offen offset:0 lds
    buffer_load_dwordx4 v33, s[44:47], s12 offen offset:1024 lds
    s_add_u32 m0, s5, 49152
    s_lshl3_add_u32 s12, s5, s13
    buffer_load_dwordx4 v32, s[44:47], s12 offen offset:0 lds
    buffer_load_dwordx4 v33, s[44:47], s12 offen offset:1024 lds
    s_add_u32 m0, s6, 49152
    s_lshl3_add_u32 s12, s6, s13
    buffer_load_dwordx4 v32, s[44:47], s12 offen offset:0 lds
    buffer_load_dwordx4 v33, s[44:47], s12 offen offset:1024 lds
    s_or_b32 s12, s2, s3
    s_cbranch_scc1 l_nn
    s_mov_b32 s80, s36
    s_and_b32 s81, s37, 0xffff
    s_mov_b32 s82, 0x100
    s_mov_b32 s83, 0x00020000
    s_bitset1_b32 s100, 0
    v_mov_b32 v1, s100
    s_mov_b64 exec, 1
    buffer_store_dword v1, off, s[80:83], 0 sc1
    s_mov_b64 exec, -1
l_nn:
    s_cmp_lg_u32 s3, 3
    s_cbranch_scc1 l_go
    s_mov_b32 m0, 147456
    s_cmp_lg_u32 s89, 7
    s_cbranch_scc1 l_bias
    s_mov_b32 s80, s32
    s_and_b32 s81, s33, 0xffff
    s_mov_b32 s82, 0x400
    s_mov_b32 s83, 0x00020000
    buffer_load_dwordx4 v2, s[80:83], 0 offen lds
    s_branch l_go
l_bias:
    s_mov_b32 s80, s26
    s_and_b32 s81, s27, 0xffff
    s_mov_b32 s82, 0xe00
    s_mov_b32 s83, 0x00020000
    s_mov_b64 exec, 0xff
    buffer_load_dwordx4 v2, s[80:83], s91 offen lds
    s_mov_b64 exec, -1
l_go:
    s_add_u32 m0, s7, 49152
    s_lshl3_add_u32 s12, s7, s13
    buffer_load_dwordx4 v32, s[44:47], s12 offen offset:0 lds
    buffer_load_dwordx4 v33, s[44:47], s12 offen offset:1024 lds
    v_mul_u32_u24 v106, 96, v9
    s_mul_i32 s61, s63, 768
    v_lshl_add_u32 v106, v10, 4, v106
    s_sub_u32 s62, 768, s61
    v_lshl_add_u32 v107, v13, 5, v106
    v_lshl_add_u32 v106, v12, 5, v106
    v_add_u32 v107, s62, v107
    v_add_u32 v106, s61, v106
    s_mov_b32 s40, s38
    s_and_b32 s41, s39, 0xffff
    s_mov_b32 s42, 0x10000000
    s_mov_b32 s43, 0x00020000
    s_mov_b32 s84, 149504
    v_lshrrev_b32 v140, 5, v0
    v_mul_u32_u24 v140, 1024, v140
    v_bfe_u32 v3, v0, 2, 2
    v_lshl_add_u32 v140, v3, 7, v140
    v_bfe_u32 v3, v0, 3, 1
    v_lshl_add_u32 v140, v3, 6, v140
    v_bfe_u32 v3, v0, 4, 1
    v_lshl_add_u32 v140, v3, 5, v140
    v_and_b32 v3, 3, v0
    v_lshl_add_u32 v140, v3, 3, v140
    v_add_u32 v140, s84, v140
    v_add_u32 v141, 512, v140
    v_xor_b32 v142, 64, v140
    v_xor_b32 v143, 64, v141
    s_mul_i32 s84, s3, 6144
    s_add_u32 s84, s84, 131072
    v_xor_b32 v141, 32, v141
    v_xor_b32 v143, 32, v143
    s_lshl_b32 s63, s3, 5
    v_and_b32 v8, 0x1ff, v140
    v_lshrrev_b32 v3, 4, v0
    v_lshl_add_u32 v8, v3, 9, v8
    v_xor_b32 v8, s63, v8
    v_add_u32 v8, s84, v8
    v_xor_b32 v9, 32, v8
    v_xor_b32 v10, 64, v8
    v_xor_b32 v11, 96, v8
    v_and_b32 v153, 0xff, v2
    v_lshl_add_u32 v153, v3, 9, v153
    v_lshlrev_b32 v40, 3, v3
    v_lshrrev_b32 v14, 3, v0
    v_mul_u32_u24 v14, 1024, v14
    v_bfe_u32 v3, v0, 4, 1
    v_lshlrev_b32 v3, 2, v3
    v_xor_b32 v3, v3, v0
    v_and_b32 v3, 7, v3
    v_lshl_add_u32 v14, v3, 4, v14
    v_add_u32 v15, 7168, v14
    v_and_b32 v3, 32, v0
    v_xor_b32 v14, v3, v14
    v_xor_b32 v15, v3, v15
    v_and_b32 v154, 0xff, v2
    v_lshl_add_u32 v154, v3, 3, v154
    v_and_b32 v3, 16, v0
    v_lshl_add_u32 v154, v3, 7, v154
    v_mov_b32 v12, 163584
    v_mov_b32 v13, 1
    v_and_b32 v128, 1, v0
    s_lshl_b32 s63, s3, 3
    v_lshl_add_u32 v128, v128, 2, s63
    v_add_u32 v128, v128, v12
    s_lshr_b32 s85, s3, 1
    s_lshl_b32 s85, s85, 13
    s_and_b32 s63, s3, 1
    s_lshl_b32 s63, s63, 11
    s_add_u32 s85, s85, s63
    v_add_u32 v129, s85, v2
    s_add_u32 s63, s14, 65536
    v_add_u32 v130, s63, v2
    v_and_b32 v131, 7, v0
    v_lshlrev_b32 v131, 2, v131
    s_lshl_b32 s18, s88, 7
    s_lshl2_add_u32 s18, s3, s18
    s_add_u32 s18, s18, 25264128
    s_and_b32 s63, s58, 7
    s_lshl4_add_u32 s63, s63, s18
    v_lshl_add_u32 v108, v131, 10, s63
    s_add_u32 s63, s59, 81920
    v_add_u32 v110, s63, v2
    s_add_u32 s63, s60, 81920
    v_add_u32 v111, s63, v2
    s_mov_b32 s24, s36
    s_and_b32 s25, s37, 0xffff
    s_mov_b32 s26, 0x100
    s_mov_b32 s27, 0x00020000
    s_mul_i32 s19, s88, 49152
    s_mul_i32 s63, s3, 1536
    s_add_u32 s19, s19, s63
    s_add_u32 s19, s19, 18874368
    v_lshl_add_u32 v132, s3, 2, v12
    v_and_b32 v133, 31, v0
    v_and_b32 v1, 15, v0
    v_lshl_add_u32 v1, v1, 10, v40
    v_lshlrev_b32 v133, 2, v133
    v_lshlrev_b32 v134, 8, v0
    v_lshlrev_b32 v139, 2, v0
    v_mov_b32 v135, 3
    v_mov_b32 v136, 7
    v_add_u32 v4, s84, v2
    s_xor_b32 s63, s3, 1
    s_mul_i32 s63, s63, 6144
    s_add_u32 s63, s63, 131072
    v_add_u32 v5, s63, v2
    s_xor_b32 s63, s3, 2
    s_mul_i32 s63, s63, 6144
    s_add_u32 s63, s63, 131072
    v_add_u32 v6, s63, v2
    s_xor_b32 s63, s3, 3
    s_mul_i32 s63, s63, 6144
    s_add_u32 s63, s63, 131072
    v_add_u32 v7, s63, v2
    v_and_b32 v3, 60, v139
    v_add_u32 v3, v3, v12
    s_lshr_b32 s12, s57, 3
    s_lshl2_add_u32 s12, s56, s12
    s_lshl2_add_u32 s12, s12, s3
    s_lshl_b32 s12, s12, 7
    s_add_u32 s12, s12, 25296896
    v_add_u32 v152, s12, v131
    s_lshl2_add_u32 s12, s87, s3
    s_lshr_b32 s62, s56, 1
    s_lshl2_add_u32 s12, s12, s62
    s_lshl_b32 s12, s12, 7
    s_add_u32 s12, s12, 25296924
    v_cmp_gt_u32 vcc, 8, v0
    v_mov_b32 v41, s12
    s_lshl_b32 s63, s63, 15
    v_cndmask_b32 v152, v41, v152, vcc
    v_mov_b32 v0, v154
    v_and_b32 v154, 60, v139
    v_mov_b32 v56, -1
    v_mov_b32 v57, -1
    v_mov_b32 v58, -1
    v_mov_b32 v59, -1
    s_and_b32 s63, s58, 7
    s_mul_i32 s63, s63, 6144
    s_add_u32 s63, s63, s19
    s_waitcnt vmcnt(10)
    buffer_store_dwordx4 v[96:99], v106, s[40:43], s63 offen sc1
    buffer_store_dwordx4 v[100:103], v107, s[40:43], s63 offen sc1
    buffer_load_dword v109, off, s[24:27], 0 sc1
    buffer_load_dword v45, v108, s[40:43], 0 offen sc1
    ds_write_b128 v110, v[96:99]
    ds_write_b128 v111, v[100:103]
    s_bfe_u32 s11, s58, 0x30004
    s_lshl_b32 s13, s11, 7
    s_add_u32 s13, s13, s8
    s_mul_i32 s12, s11, 229376
    s_add_u32 m0, s15, 139264
    s_add_u32 s12, s12, s10
    buffer_load_dwordx4 v36, s[52:55], s12 offen offset:0 lds
    buffer_load_dwordx4 v37, s[52:55], s12 offen offset:1024 lds
    s_add_u32 m0, s4, 98304
    s_lshl3_add_u32 s12, s4, s13
    buffer_load_dwordx4 v32, s[44:47], s12 offen offset:0 lds
    buffer_load_dwordx4 v33, s[44:47], s12 offen offset:1024 lds
    s_mul_i32 s12, s11, 196608
    s_add_u32 m0, s59, 131072
    s_add_u32 s12, s12, s9
    buffer_load_dwordx4 v104, s[48:51], s12 offen lds
    s_add_u32 m0, s5, 98304
    s_lshl3_add_u32 s12, s5, s13
    buffer_load_dwordx4 v32, s[44:47], s12 offen offset:0 lds
    buffer_load_dwordx4 v33, s[44:47], s12 offen offset:1024 lds
    s_waitcnt vmcnt(11)
    s_waitcnt lgkmcnt(0)
    s_barrier
    s_mul_i32 s12, s11, 196608
    s_add_u32 m0, s60, 131072
    s_add_u32 s12, s12, s9
    buffer_load_dwordx4 v105, s[48:51], s12 offen lds
    s_add_u32 m0, s6, 98304
    s_lshl3_add_u32 s12, s6, s13
    buffer_load_dwordx4 v32, s[44:47], s12 offen offset:0 lds
    buffer_load_dwordx4 v33, s[44:47], s12 offen offset:1024 lds
    s_add_u32 m0, s7, 98304
    s_lshl3_add_u32 s12, s7, s13
    buffer_load_dwordx4 v32, s[44:47], s12 offen offset:0 lds
    buffer_load_dwordx4 v33, s[44:47], s12 offen offset:1024 lds
    s_waitcnt vmcnt(12)
    v_readfirstlane_b32 s16, v109
    s_mov_b64 exec, 0xff
    s_cmp_lg_u32 s16, 0
    s_cselect_b32 s63, 0, 0x20000
    buffer_store_dword v109, v108, s[40:43], s63 offen
    s_mov_b64 exec, -1
    buffer_load_dword v109, off, s[24:27], 0 sc1
    s_bfe_u32 s11, s58, 0x30008
    s_lshl_b32 s13, s11, 7
    s_add_u32 s13, s13, s8
    s_mul_i32 s12, s11, 229376
    s_add_u32 m0, s15, 40960
    s_add_u32 s12, s12, s10
    buffer_load_dwordx4 v36, s[52:55], s12 offen offset:0 lds
    buffer_load_dwordx4 v37, s[52:55], s12 offen offset:1024 lds
    s_add_u32 m0, s4, 0
    s_lshl3_add_u32 s12, s4, s13
    buffer_load_dwordx4 v32, s[44:47], s12 offen offset:0 lds
    buffer_load_dwordx4 v33, s[44:47], s12 offen offset:1024 lds
    s_add_u32 m0, s5, 0
    s_lshl3_add_u32 s12, s5, s13
    buffer_load_dwordx4 v32, s[44:47], s12 offen offset:0 lds
    buffer_load_dwordx4 v33, s[44:47], s12 offen offset:1024 lds
    s_add_u32 m0, s6, 0
    s_lshl3_add_u32 s12, s6, s13
    buffer_load_dwordx4 v32, s[44:47], s12 offen offset:0 lds
    buffer_load_dwordx4 v33, s[44:47], s12 offen offset:1024 lds
    s_add_u32 m0, s7, 0
    s_lshl3_add_u32 s12, s7, s13
    buffer_load_dwordx4 v32, s[44:47], s12 offen offset:0 lds
    buffer_load_dwordx4 v33, s[44:47], s12 offen offset:1024 lds
    s_waitcnt vmcnt(12)
    s_barrier
    s_lshl4_add_u32 s12, s11, s18
    s_buffer_load_dword s17, s[40:43], s12 offset:8192
    s_add_u32 m0, s59, 32768
    s_waitcnt lgkmcnt(0)
    s_cmp_eq_u32 s17, s16
    s_cselect_b32 s12, s16, 0
    s_cmp_lg_u32 s12, 0
    s_cbranch_scc1 l_pk2
    s_mul_i32 s12, s11, 196608
    s_add_u32 s12, s12, s9
    buffer_load_dwordx4 v104, s[48:51], s12 offen lds
    s_add_u32 m0, s60, 32768
    s_nop 0
    buffer_load_dwordx4 v105, s[48:51], s12 offen lds
    s_branch l_pd2
l_pk2:
    s_mul_i32 s12, s11, 6144
    s_add_u32 s12, s12, s19
    buffer_load_dwordx4 v106, s[40:43], s12 offen lds
    s_add_u32 m0, s60, 32768
    s_nop 0
    buffer_load_dwordx4 v107, s[40:43], s12 offen lds
l_pd2:
    s_bfe_u32 s11, s58, 0x3000c
    s_lshl_b32 s13, s11, 7
    s_add_u32 s13, s13, s8
    s_lshl4_add_u32 s12, s11, s18
    s_buffer_load_dword s17, s[40:43], s12 offset:12288
    s_mul_i32 s12, s11, 229376
    s_add_u32 m0, s15, 90112
    s_add_u32 s12, s12, s10
    buffer_load_dwordx4 v36, s[52:55], s12 offen offset:0 lds
    buffer_load_dwordx4 v37, s[52:55], s12 offen offset:1024 lds
    s_add_u32 m0, s4, 49152
    s_lshl3_add_u32 s12, s4, s13
    buffer_load_dwordx4 v32, s[44:47], s12 offen offset:0 lds
    buffer_load_dwordx4 v33, s[44:47], s12 offen offset:1024 lds
    s_add_u32 m0, s5, 49152
    s_lshl3_add_u32 s12, s5, s13
    buffer_load_dwordx4 v32, s[44:47], s12 offen offset:0 lds
    buffer_load_dwordx4 v33, s[44:47], s12 offen offset:1024 lds
    s_add_u32 m0, s6, 49152
    s_lshl3_add_u32 s12, s6, s13
    buffer_load_dwordx4 v32, s[44:47], s12 offen offset:0 lds
    buffer_load_dwordx4 v33, s[44:47], s12 offen offset:1024 lds
    s_add_u32 m0, s59, 81920
    s_waitcnt lgkmcnt(0)
    s_cmp_eq_u32 s17, s16
    s_cselect_b32 s12, s16, 0
    s_cmp_lg_u32 s12, 0
    s_cbranch_scc1 l_pk3
    s_mul_i32 s12, s11, 196608
    s_add_u32 s12, s12, s9
    buffer_load_dwordx4 v104, s[48:51], s12 offen lds
    s_add_u32 m0, s60, 81920
    s_nop 0
    buffer_load_dwordx4 v105, s[48:51], s12 offen lds
    s_branch l_pd3
l_pk3:
    s_mul_i32 s12, s11, 6144
    s_add_u32 s12, s12, s19
    buffer_load_dwordx4 v106, s[40:43], s12 offen lds
    s_add_u32 m0, s60, 81920
    s_nop 0
    buffer_load_dwordx4 v107, s[40:43], s12 offen lds
l_pd3:
    s_mov_b32 s80, s30
    s_and_b32 s81, s31, 0xffff
    s_mov_b32 s82, 0x400
    s_mov_b32 s83, 0x00020000
    s_and_b32 s12, s57, 7
    s_lshl2_add_u32 s12, s12, s3
    s_lshl_b32 s12, s12, 5
    buffer_load_dwordx2 v[144:145], v40, s[80:83], s12 offen offset:0
    s_waitcnt vmcnt(11)
    s_barrier
    s_add_u32 m0, s7, 49152
    s_lshl3_add_u32 s12, s7, s13
    buffer_load_dwordx4 v32, s[44:47], s12 offen offset:0 lds
    buffer_load_dwordx4 v33, s[44:47], s12 offen offset:1024 lds
    s_waitcnt vmcnt(25)
    v_readfirstlane_b32 s16, v109
    s_mov_b64 exec, 0xff
    s_cmp_lg_u32 s16, 0
    s_cselect_b32 s63, 0, 0x20000
    buffer_store_dword v109, v108, s[40:43], s63 offen
    s_mov_b64 exec, -1
    s_bfe_u32 s11, s58, 0x30010
    s_lshl_b32 s13, s11, 7
    s_add_u32 s13, s13, s8
    s_lshl4_add_u32 s12, s11, s18
    s_buffer_load_dword s17, s[40:43], s12 offset:16384
    s_mul_i32 s12, s11, 229376
    s_add_u32 m0, s15, 139264
    s_add_u32 s12, s12, s10
    buffer_load_dwordx4 v36, s[52:55], s12 offen offset:0 lds
    buffer_load_dwordx4 v37, s[52:55], s12 offen offset:1024 lds
    s_add_u32 m0, s4, 98304
    s_lshl3_add_u32 s12, s4, s13
    buffer_load_dwordx4 v32, s[44:47], s12 offen offset:0 lds
    buffer_load_dwordx4 v33, s[44:47], s12 offen offset:1024 lds
    s_add_u32 m0, s5, 98304
    s_lshl3_add_u32 s12, s5, s13
    buffer_load_dwordx4 v32, s[44:47], s12 offen offset:0 lds
    buffer_load_dwordx4 v33, s[44:47], s12 offen offset:1024 lds
    s_add_u32 m0, s6, 98304
    s_lshl3_add_u32 s12, s6, s13
    buffer_load_dwordx4 v32, s[44:47], s12 offen offset:0 lds
    buffer_load_dwordx4 v33, s[44:47], s12 offen offset:1024 lds
    s_add_u32 m0, s59, 131072
    s_waitcnt lgkmcnt(0)
    s_cmp_eq_u32 s17, s16
    s_cselect_b32 s12, s16, 0
    s_cmp_lg_u32 s12, 0
    s_cbranch_scc1 l_pk4
    s_mul_i32 s12, s11, 196608
    s_add_u32 s12, s12, s9
    buffer_load_dwordx4 v104, s[48:51], s12 offen lds
    s_add_u32 m0, s60, 131072
    s_nop 0
    buffer_load_dwordx4 v105, s[48:51], s12 offen lds
    s_branch l_pd4
l_pk4:
    s_mul_i32 s12, s11, 6144
    s_add_u32 s12, s12, s19
    buffer_load_dwordx4 v106, s[40:43], s12 offen lds
    s_add_u32 m0, s60, 131072
    s_nop 0
    buffer_load_dwordx4 v107, s[40:43], s12 offen lds
l_pd4:
    s_waitcnt vmcnt(11)
    s_barrier
    s_add_u32 m0, s7, 98304
    s_lshl3_add_u32 s12, s7, s13
    buffer_load_dwordx4 v32, s[44:47], s12 offen offset:0 lds
    buffer_load_dwordx4 v33, s[44:47], s12 offen offset:1024 lds
    s_bfe_u32 s11, s58, 0x30014
    s_lshl_b32 s13, s11, 7
    s_add_u32 s13, s13, s8
    s_lshl4_add_u32 s12, s11, s18
    s_buffer_load_dword s17, s[40:43], s12 offset:20480
    s_mul_i32 s12, s11, 229376
    s_add_u32 m0, s15, 40960
    s_add_u32 s12, s12, s10
    buffer_load_dwordx4 v36, s[52:55], s12 offen offset:0 lds
    buffer_load_dwordx4 v37, s[52:55], s12 offen offset:1024 lds
    s_add_u32 m0, s4, 0
    s_lshl3_add_u32 s12, s4, s13
    buffer_load_dwordx4 v32, s[44:47], s12 offen offset:0 lds
    buffer_load_dwordx4 v33, s[44:47], s12 offen offset:1024 lds
    s_add_u32 m0, s5, 0
    s_lshl3_add_u32 s12, s5, s13
    buffer_load_dwordx4 v32, s[44:47], s12 offen offset:0 lds
    buffer_load_dwordx4 v33, s[44:47], s12 offen offset:1024 lds
    s_add_u32 m0, s6, 0
    s_lshl3_add_u32 s12, s6, s13
    buffer_load_dwordx4 v32, s[44:47], s12 offen offset:0 lds
    buffer_load_dwordx4 v33, s[44:47], s12 offen offset:1024 lds
    s_add_u32 m0, s59, 32768
    s_waitcnt lgkmcnt(0)
    s_cmp_eq_u32 s17, s16
    s_cselect_b32 s12, s16, 0
    s_cmp_lg_u32 s12, 0
    s_cbranch_scc1 l_pk5
    s_mul_i32 s12, s11, 196608
    s_add_u32 s12, s12, s9
    buffer_load_dwordx4 v104, s[48:51], s12 offen lds
    s_add_u32 m0, s60, 32768
    s_nop 0
    buffer_load_dwordx4 v105, s[48:51], s12 offen lds
    s_branch l_pd5
l_pk5:
    s_mul_i32 s12, s11, 6144
    s_add_u32 s12, s12, s19
    buffer_load_dwordx4 v106, s[40:43], s12 offen lds
    s_add_u32 m0, s60, 32768
    s_nop 0
    buffer_load_dwordx4 v107, s[40:43], s12 offen lds
l_pd5:
    v_lshlrev_b32 v16, 16, v144
    v_and_b32 v17, 0xffff0000, v144
    v_lshlrev_b32 v18, 16, v145
    v_and_b32 v19, 0xffff0000, v145
    v_lshlrev_b32 v20, 16, v144
    v_and_b32 v21, 0xffff0000, v144
    v_lshlrev_b32 v22, 16, v145
    v_and_b32 v23, 0xffff0000, v145
    v_lshlrev_b32 v24, 16, v144
    v_and_b32 v25, 0xffff0000, v144
    v_lshlrev_b32 v26, 16, v145
    v_and_b32 v27, 0xffff0000, v145
    v_lshlrev_b32 v28, 16, v144
    v_and_b32 v29, 0xffff0000, v144
    v_lshlrev_b32 v30, 16, v145
    v_and_b32 v31, 0xffff0000, v145
    s_waitcnt vmcnt(10)
    s_barrier
    s_add_u32 m0, s7, 0
    s_lshl3_add_u32 s12, s7, s13
    buffer_load_dwordx4 v32, s[44:47], s12 offen offset:0 lds
    buffer_load_dwordx4 v33, s[44:47], s12 offen offset:1024 lds
    s_bfe_u32 s11, s58, 0x30018
    s_lshl_b32 s13, s11, 7
    s_add_u32 s13, s13, s8
    s_lshl4_add_u32 s12, s11, s18
    s_buffer_load_dword s17, s[40:43], s12 offset:24576
    s_mul_i32 s12, s11, 229376
    s_add_u32 m0, s15, 90112
    s_add_u32 s12, s12, s10
    buffer_load_dwordx4 v36, s[52:55], s12 offen offset:0 lds
    buffer_load_dwordx4 v37, s[52:55], s12 offen offset:1024 lds
    s_add_u32 m0, s4, 49152
    s_lshl3_add_u32 s12, s4, s13
    buffer_load_dwordx4 v32, s[44:47], s12 offen offset:0 lds
    buffer_load_dwordx4 v33, s[44:47], s12 offen offset:1024 lds
    s_add_u32 m0, s5, 49152
    s_lshl3_add_u32 s12, s5, s13
    buffer_load_dwordx4 v32, s[44:47], s12 offen offset:0 lds
    buffer_load_dwordx4 v33, s[44:47], s12 offen offset:1024 lds
    s_add_u32 m0, s6, 49152
    s_lshl3_add_u32 s12, s6, s13
    buffer_load_dwordx4 v32, s[44:47], s12 offen offset:0 lds
    buffer_load_dwordx4 v33, s[44:47], s12 offen offset:1024 lds
    s_add_u32 m0, s59, 81920
    s_waitcnt lgkmcnt(0)
    s_cmp_eq_u32 s17, s16
    s_cselect_b32 s12, s16, 0
    s_cmp_lg_u32 s12, 0
    s_cbranch_scc1 l_pk6
    s_mul_i32 s12, s11, 196608
    s_add_u32 s12, s12, s9
    buffer_load_dwordx4 v104, s[48:51], s12 offen lds
    s_add_u32 m0, s60, 81920
    s_nop 0
    buffer_load_dwordx4 v105, s[48:51], s12 offen lds
    s_branch l_pd6
l_pk6:
    s_mul_i32 s12, s11, 6144
    s_add_u32 s12, s12, s19
    buffer_load_dwordx4 v106, s[40:43], s12 offen lds
    s_add_u32 m0, s60, 81920
    s_nop 0
    buffer_load_dwordx4 v107, s[40:43], s12 offen lds
l_pd6:
    s_waitcnt vmcnt(10)
    s_barrier
    s_add_u32 m0, s7, 49152
    s_lshl3_add_u32 s12, s7, s13
    buffer_load_dwordx4 v32, s[44:47], s12 offen offset:0 lds
    buffer_load_dwordx4 v33, s[44:47], s12 offen offset:1024 lds
    s_bfe_u32 s11, s58, 0x3001c
    s_lshl_b32 s13, s11, 7
    s_add_u32 s13, s13, s8
    s_lshl4_add_u32 s12, s11, s18
    s_buffer_load_dword s17, s[40:43], s12 offset:28672
    s_mul_i32 s12, s11, 229376
    s_add_u32 m0, s15, 139264
    s_add_u32 s12, s12, s10
    buffer_load_dwordx4 v36, s[52:55], s12 offen offset:0 lds
    buffer_load_dwordx4 v37, s[52:55], s12 offen offset:1024 lds
    s_add_u32 m0, s4, 98304
    s_lshl3_add_u32 s12, s4, s13
    buffer_load_dwordx4 v32, s[44:47], s12 offen offset:0 lds
    buffer_load_dwordx4 v33, s[44:47], s12 offen offset:1024 lds
    s_add_u32 m0, s5, 98304
    s_lshl3_add_u32 s12, s5, s13
    buffer_load_dwordx4 v32, s[44:47], s12 offen offset:0 lds
    buffer_load_dwordx4 v33, s[44:47], s12 offen offset:1024 lds
    s_add_u32 m0, s6, 98304
    s_lshl3_add_u32 s12, s6, s13
    buffer_load_dwordx4 v32, s[44:47], s12 offen offset:0 lds
    buffer_load_dwordx4 v33, s[44:47], s12 offen offset:1024 lds
    s_add_u32 m0, s59, 131072
    s_waitcnt lgkmcnt(0)
    s_cmp_eq_u32 s17, s16
    s_cselect_b32 s12, s16, 0
    s_cmp_lg_u32 s12, 0
    s_cbranch_scc1 l_pk7
    s_mul_i32 s12, s11, 196608
    s_add_u32 s12, s12, s9
    buffer_load_dwordx4 v104, s[48:51], s12 offen lds
    s_add_u32 m0, s60, 131072
    s_nop 0
    buffer_load_dwordx4 v105, s[48:51], s12 offen lds
    s_branch l_pd7
l_pk7:
    s_mul_i32 s12, s11, 6144
    s_add_u32 s12, s12, s19
    buffer_load_dwordx4 v106, s[40:43], s12 offen lds
    s_add_u32 m0, s60, 131072
    s_nop 0
    buffer_load_dwordx4 v107, s[40:43], s12 offen lds
l_pd7:
    s_waitcnt vmcnt(10)
    s_barrier
    s_add_u32 m0, s7, 98304
    s_lshl3_add_u32 s12, s7, s13
    buffer_load_dwordx4 v32, s[44:47], s12 offen offset:0 lds
    buffer_load_dwordx4 v33, s[44:47], s12 offen offset:1024 lds
    s_mov_b32 s80, s36
    s_and_b32 s81, s37, 0xffff
    s_mov_b32 s82, 0x100
    s_mov_b32 s83, 0x00020000
    buffer_load_dword v158, off, s[80:83], 0 sc1
    s_lshl2_add_u32 s4, s87, s3
    s_mul_i32 s44, s4, 294912
    s_add_u32 s44, s44, 8388608
    s_lshl_b32 s5, s88, 10
    s_add_u32 s6, s44, s5
    s_add_u32 s6, s6, 114688
    s_add_u32 s7, s6, 147456
    buffer_store_dwordx4 v[56:59], v2, s[40:43], s6 offen sc1
    buffer_store_dwordx4 v[56:59], v2, s[40:43], s7 offen sc1
    s_mov_b32 s48, s20
    s_and_b32 s49, s21, 0xffff
    s_mov_b32 s50, 0x80000
    s_mov_b32 s51, 0x00020000
    s_lshr_b32 s6, s2, 3
    s_and_b32 s7, s2, 7
    s_lshl_b32 s8, s6, 14
    s_lshl_b32 s9, s7, 7
    s_add_u32 s8, s8, s9
    s_mov_b32 m0, 149504
    s_mul_i32 s52, s7, 294912
    s_cmp_lg_u32 s3, 3
    s_cbranch_scc1 l_nw
    buffer_load_dwordx4 v14, s[48:51], s8 offen offset:0 lds
    buffer_load_dwordx4 v15, s[48:51], s8 offen offset:1024 lds
    s_waitcnt vmcnt(5)
    s_branch l_nw2
l_nw:
    s_waitcnt vmcnt(3)
l_nw2:
    s_barrier
    s_setprio 3
    s_mov_b32 s90, s3
    s_lshl_b32 s6, s6, 10
    s_add_u32 s52, s52, s6
    s_add_u32 s52, s52, 4308992
    s_add_u32 s53, s52, 147456
    s_lshl_b32 s5, s91, 5
    s_add_u32 s44, s44, s5
    s_add_u32 s45, s44, 147456
    s_lshl_b32 s46, s4, 9
    s_lshr_b32 s5, s56, 1
    s_lshl_b32 s9, s5, 7
    s_add_u32 s46, s46, s9
    s_lshl2_add_u32 s46, s89, s46
    s_add_u32 s46, s46, 25296896
    s_lshl_b32 s47, s5, 13
    s_lshl_b32 s9, s4, 8
    s_add_u32 s47, s47, s9
    s_add_u32 s47, s47, 25165824
    s_mov_b32 s4, s85
    s_lshl_b32 s8, s88, 17
    s_add_u32 s8, s8, 20971520
    s_lshl_b32 s6, s87, 14
    s_add_u32 s6, s6, s8
    s_add_u32 s6, s6, s4
    s_add_u32 s7, s6, 4096
    s_lshl_b32 s12, s88, 8
    s_add_u32 s12, s12, 25231360
    s_lshl_b32 s13, s3, 5
    s_add_u32 s12, s12, s13
    s_lshl2_add_u32 s13, s87, s12
    s_add_u32 s8, s8, s4
    s_movk_i32 s9, 0xff
    s_bitset0_b32 s9, s87
    s_mov_b32 s10, 0
    s_mov_b32 s11, 0
    s_mov_b32 s62, 131072
g_np:
    s_waitcnt vmcnt(0)
    v_readfirstlane_b32 s92, v158
    s_cmp_lg_u32 s92, 0
    s_cbranch_scc1 g_npd
    buffer_load_dword v158, off, s[80:83], 0 sc1
    s_sub_u32 s62, s62, 1
    s_cmp_lg_u32 s62, 0
    s_cbranch_scc1 g_np
g_npd:
    s_mov_b32 s81, s47
    s_cmp_lg_u32 s3, 3
    s_cbranch_scc1 g_ncv
    ds_read_b64_tr_b16 v[48:49], v140
    ds_read_b64_tr_b16 v[50:51], v141
    ds_read_b64_tr_b16 v[52:53], v142
    ds_read_b64_tr_b16 v[54:55], v143
    s_waitcnt lgkmcnt(0)
    buffer_store_dwordx4 v[48:51], v2, s[40:43], s52 offen sc1
    buffer_store_dwordx4 v[52:55], v2, s[40:43], s53 offen sc1
g_ncv:
    s_mov_b32 s62, 131072
lp_1:
    ds_read_b32 v137, v128 offset:32
    s_waitcnt lgkmcnt(0)
    v_cmp_gt_u32 vcc, 1, v137
    s_cbranch_vccz lpd_2
    s_sleep 0
    s_sub_u32 s62, s62, 1
    s_cmp_lg_u32 s62, 0
    s_cbranch_scc1 lp_1
lpd_2:
    ds_read_b128 v[32:35], v129 offset:0
    ds_read_b128 v[36:39], v129 offset:1024
    ds_read_b128 v[40:43], v129 offset:4096
    ds_read_b128 v[44:47], v129 offset:5120
    s_waitcnt lgkmcnt(3)
    buffer_store_dwordx4 v[32:35], v2, s[40:43], s6 offen offset:0 sc1
    s_waitcnt lgkmcnt(2)
    buffer_store_dwordx4 v[36:39], v2, s[40:43], s6 offen offset:1024 sc1
    s_waitcnt lgkmcnt(1)
    buffer_store_dwordx4 v[40:43], v2, s[40:43], s7 offen offset:0 sc1
    s_waitcnt lgkmcnt(0)
    buffer_store_dwordx4 v[44:47], v2, s[40:43], s7 offen offset:1024 sc1
    s_mov_b64 exec, 1
    s_waitcnt vmcnt(0)
    buffer_store_dword v158, v2, s[40:43], s13 offen
    s_mov_b64 exec, -1
    s_mov_b32 s61, 131072
g_kp:
    s_cmp_lg_u32 s61, 131066
    s_cbranch_scc1 g_kq
    s_mov_b64 exec, 1
    buffer_store_dword v158, v2, s[40:43], s13 offen offset:128 sc1
    s_mov_b64 exec, -1
g_kq:
    buffer_load_dword v137, v131, s[40:43], s12 offen sc1
    v_mov_b32 v138, s11
    s_cmp_eq_u32 s61, 131024
    s_cselect_b32 s5, 128, 0
    s_add_u32 s12, s12, s5
    s_sub_u32 s61, s61, 1
    s_cselect_b32 s10, 0xff, 0
    s_waitcnt vmcnt(0)
    ds_write_b32 v132, v138 offset:160
    s_cmp_le_u32 s11, 3
    s_cbranch_scc1 g_kf
    s_mov_b64 exec, 1
    buffer_store_dword v158, v2, s[40:43], s46 offen sc1
    s_mov_b64 exec, -1
g_kf:
    v_cmp_eq_u32 vcc, s92, v137
    s_or_b32 s10, s10, vcc_lo
    s_and_b32 s10, s10, s9
    s_cbranch_scc1 g_ki
    s_sleep 1
    s_branch g_kp
g_ki:
    s_cmp_lg_u32 s11, 3
    s_cbranch_scc1 g_kh
    s_waitcnt vmcnt(8)
    s_mov_b64 exec, 1
    ds_max_u32 v132, v13 offset:160
    s_mov_b64 exec, -1
    s_mov_b32 s62, 131072
lp_3:
    ds_read_b32 v137, v128 offset:64
    s_waitcnt lgkmcnt(0)
    v_cmp_gt_u32 vcc, 1, v137
    s_cbranch_vccz lpd_4
    s_sleep 1
    s_sub_u32 s62, s62, 1
    s_cmp_lg_u32 s62, 0
    s_cbranch_scc1 lp_3
lpd_4:
    s_setprio 0
    ds_read_b128 v[80:83], v130 offset:0
    ds_read_b128 v[84:87], v130 offset:1024
    ds_read_b128 v[88:91], v130 offset:2048
    ds_read_b128 v[92:95], v130 offset:3072
    ds_read_b128 v[96:99], v130 offset:4096
    ds_read_b128 v[100:103], v130 offset:5120
    ds_read_b128 v[104:107], v130 offset:6144
    ds_read_b128 v[108:111], v130 offset:7168
    s_cmp_eq_u32 s89, 7
    s_cbranch_scc1 g_gs
    s_waitcnt lgkmcnt(7)
    buffer_store_dwordx4 v[80:83], v2, s[40:43], s44 offen offset:0 sc1
    s_waitcnt lgkmcnt(6)
    buffer_store_dwordx4 v[84:87], v2, s[40:43], s44 offen offset:1024 sc1
    s_waitcnt lgkmcnt(5)
    buffer_store_dwordx4 v[88:91], v2, s[40:43], s44 offen offset:2048 sc1
    s_waitcnt lgkmcnt(4)
    buffer_store_dwordx4 v[92:95], v2, s[40:43], s44 offen offset:3072 sc1
    s_waitcnt lgkmcnt(3)
    buffer_store_dwordx4 v[96:99], v2, s[40:43], s45 offen offset:0 sc1
    s_waitcnt lgkmcnt(2)
    buffer_store_dwordx4 v[100:103], v2, s[40:43], s45 offen offset:1024 sc1
    s_waitcnt lgkmcnt(1)
    buffer_store_dwordx4 v[104:107], v2, s[40:43], s45 offen offset:2048 sc1
    s_waitcnt lgkmcnt(0)
    buffer_store_dwordx4 v[108:111], v2, s[40:43], s45 offen offset:3072 sc1
    s_mov_b64 exec, 1
    ds_add_u32 v12, v13 offset:16
    s_mov_b64 exec, -1
    s_waitcnt vmcnt(8)
    s_branch g_hs
g_gs:
    s_waitcnt lgkmcnt(0)
    s_mov_b64 exec, 0xff
    buffer_store_dwordx4 v[80:83], v2, s[40:43], s47 offen sc1
    buffer_store_dwordx4 v[96:99], v2, s[40:43], s47 offen offset:128 sc1
    s_mov_b64 exec, 1
    ds_add_u32 v12, v13 offset:16
    s_mov_b64 exec, -1
    s_waitcnt vmcnt(2)
g_hs:
    s_setprio 3
    ds_write_b32 v132, v135 offset:160
    s_mov_b32 s62, 131072
lp_5:
    ds_read_b32 v137, v12 offset:16
    s_waitcnt lgkmcnt(0)
    v_cmp_gt_u32 vcc, 4, v137
    s_cbranch_vccz lpd_6
    s_sleep 1
    s_sub_u32 s62, s62, 1
    s_cmp_lg_u32 s62, 0
    s_cbranch_scc1 lp_5
lpd_6:
g_kh:
    s_ff1_i32_b32 s5, s10
    s_bitset0_b32 s9, s5
    s_bitset0_b32 s10, s5
    s_add_u32 s11, s11, 1
    s_lshl_b32 s6, s11, 14
    s_add_u32 m0, s6, s4
    s_lshl_b32 s5, s5, 14
    s_add_u32 s5, s5, s8
    buffer_load_dwordx4 v2, s[40:43], s5 offen offset:0 lds
    buffer_load_dwordx4 v2, s[40:43], s5 offen offset:1024 lds
    s_add_u32 m0, m0, 4096
    s_add_u32 s5, s5, 4096
    buffer_load_dwordx4 v2, s[40:43], s5 offen offset:0 lds
    buffer_load_dwordx4 v2, s[40:43], s5 offen offset:1024 lds
    s_cmp_lg_u32 s10, 0
    s_cbranch_scc1 g_ki
    s_cmp_lg_u32 s9, 0
    s_cbranch_scc1 g_kp
    s_waitcnt vmcnt(16)
    s_mov_b64 exec, 1
    buffer_store_dword v158, v2, s[40:43], s46 offen sc1
    s_mov_b64 exec, -1
    s_mov_b64 exec, 1
    buffer_store_dword v158, v2, s[40:43], s13 offen offset:128 sc1
    s_mov_b64 exec, -1
    s_mov_b32 s44, s28
    s_and_b32 s45, s29, 0xffff
    s_mov_b32 s46, 0x1c0000
    s_mov_b32 s47, 0x00020000
    s_waitcnt vmcnt(2)
    ds_write_b32 v132, v136 offset:160
    s_setprio 3
    s_cmp_lg_u32 s3, 3
    s_cbranch_scc1 g_f2
    s_lshl_b32 s12, s56, 8
    s_lshl_b32 s7, s57, 2
    s_add_u32 s6, s12, s7
    s_add_u32 s6, s6, 25251840
    s_mov_b64 exec, 1
    buffer_store_dword v158, v2, s[40:43], s6 offen
    buffer_store_dword v158, v2, s[40:43], s6 offen offset:128 sc1
    s_mov_b64 exec, -1
    s_cmp_lg_u32 s57, 31
    s_cbranch_scc1 g_f2
    s_add_u32 s6, s12, 25251840
    s_mov_b32 s62, 131072
gp_7:
    buffer_load_dword v137, v133, s[40:43], s6 offen sc1
    s_waitcnt vmcnt(0)
    v_cmp_ne_u32 vcc, s92, v137
    s_cbranch_vccz gpd_8
    s_sleep 2
    s_cmp_eq_u32 s62, 131024
    s_cselect_b32 s63, 128, 0
    s_add_u32 s6, s6, s63
    s_sub_u32 s62, s62, 1
    s_cmp_lg_u32 s62, 0
    s_cbranch_scc1 gp_7
gpd_8:
    s_lshl_b32 s7, s56, 2
    s_add_u32 s7, s7, 25255936
    s_mov_b64 exec, 0xff
    buffer_store_dword v158, v134, s[40:43], s7 offen sc1
    s_mov_b64 exec, -1
g_f2:
    s_mov_b32 s52, s34
    s_and_b32 s53, s35, 0xffff
    s_mov_b32 s54, 0x200000
    s_mov_b32 s55, 0x00020000
    s_lshr_b32 s4, s57, 3
    s_and_b32 s5, s57, 7
    s_lshl_b32 s14, s4, 1
    s_add_u32 s14, s14, s5
    s_cmp_ge_u32 s14, 7
    s_cselect_b32 s6, 7, 0
    s_sub_u32 s14, s14, s6
    s_mul_i32 s14, s14, 4
    s_lshl_b32 s6, s56, 2
    s_add_u32 s4, s4, s6
    s_lshr_b32 s6, s90, 1
    s_mov_b32 s7, 0
    s_lshl_b32 s12, s5, 1
    s_add_u32 s59, s12, s6
    s_mul_i32 s61, s59, 147456
    s_add_u32 s61, s61, 4194304
    s_mul_i32 s8, s90, 458752
    s_lshl_b32 s9, s5, 7
    s_add_u32 s8, s8, s9
    s_mul_i32 s12, s90, 28672
    s_lshl_b32 s13, s4, 1
    s_add_u32 s60, s13, s7
    s_xor_b32 s13, s60, 1
    s_mul_i32 s10, s60, 147456
    s_mul_i32 s11, s13, 147456
    s_add_u32 s12, s12, 8388608
    s_add_u32 s10, s10, s12
    s_add_u32 s11, s11, s12
    s_mov_b32 s12, 0
    s_lshl_b32 s13, s3, 10
    s_add_u32 m0, s13, 160000
    s_mov_b32 s62, 131072
gp_9:
    buffer_load_dword v137, v152, s[40:43], s12 offen sc1
    s_waitcnt vmcnt(0)
    v_cmp_ne_u32 vcc, s92, v137
    s_cbranch_vccz gpd_10
    s_sleep 4
    s_sub_u32 s62, s62, 1
    s_cmp_lg_u32 s62, 0
    s_cbranch_scc1 gp_9
gpd_10:
    buffer_load_dword v139, s[40:43], s81 offen sc1 lds
    s_lshl_b32 s13, s60, 7
    s_lshl_b32 s12, s3, 13
    s_add_u32 s13, s13, s12
    s_add_u32 s13, s13, 25165824
    buffer_load_dword v152, v154, s[40:43], s13 offen offset:0 sc1
    buffer_load_dword v156, v154, s[40:43], s13 offen offset:64 sc1
    buffer_load_dword v157, v154, s[40:43], s13 offen offset:128 sc1
    buffer_load_dword v159, v154, s[40:43], s13 offen offset:192 sc1
    s_lshl_b32 s12, s56, 8
    s_add_u32 s12, s12, 25255936
    s_setprio 3
    s_lshl_b32 s15, s14, 10
    s_lshl_b32 s13, s14, 14
    s_add_u32 m0, s84, 0
    s_add_u32 s13, s13, s8
    buffer_load_dwordx4 v14, s[44:47], s13 offen offset:0 lds
    buffer_load_dwordx4 v15, s[44:47], s13 offen offset:1024 lds
    s_add_u32 s14, s14, 1
    s_cmp_eq_u32 s14, 28
    s_cselect_b32 s14, 0, s14
    s_lshl_b32 s13, s14, 14
    s_add_u32 m0, s84, 2048
    s_add_u32 s13, s13, s8
    buffer_load_dwordx4 v14, s[44:47], s13 offen offset:0 lds
    buffer_load_dwordx4 v15, s[44:47], s13 offen offset:1024 lds
    s_add_u32 s13, s15, s10
    buffer_load_dwordx4 v[96:99], v153, s[40:43], s13 offen offset:0
    buffer_load_dwordx4 v[100:103], v153, s[40:43], s13 offen offset:256
    s_add_u32 s14, s14, 1
    s_cmp_eq_u32 s14, 28
    s_cselect_b32 s14, 0, s14
    s_lshl_b32 s13, s14, 14
    s_add_u32 m0, s84, 4096
    s_add_u32 s13, s13, s8
    buffer_load_dwordx4 v14, s[44:47], s13 offen offset:0 lds
    buffer_load_dwordx4 v15, s[44:47], s13 offen offset:1024 lds
    s_add_u32 s13, s15, s11
    buffer_load_dwordx4 v[104:107], v153, s[40:43], s13 offen offset:0
    buffer_load_dwordx4 v[108:111], v153, s[40:43], s13 offen offset:256
    s_add_u32 s15, s15, 2048
    s_cmp_eq_u32 s15, 28672
    s_cselect_b32 s15, 0, s15
    s_add_u32 s13, s15, s10
    buffer_load_dwordx4 v[112:115], v153, s[40:43], s13 offen offset:0
    buffer_load_dwordx4 v[116:119], v153, s[40:43], s13 offen offset:256
    s_waitcnt vmcnt(10)
    ds_read_b64_tr_b16 v[80:81], v8 offset:0
    ds_read_b64_tr_b16 v[84:85], v9 offset:0
    ds_read_b64_tr_b16 v[88:89], v10 offset:0
    ds_read_b64_tr_b16 v[92:93], v11 offset:0
    s_waitcnt vmcnt(8)
    ds_read_b64_tr_b16 v[82:83], v8 offset:2048
    ds_read_b64_tr_b16 v[86:87], v9 offset:2048
    ds_read_b64_tr_b16 v[90:91], v10 offset:2048
    ds_read_b64_tr_b16 v[94:95], v11 offset:2048
    s_waitcnt lgkmcnt(4)
    s_add_u32 s14, s14, 1
    s_cmp_eq_u32 s14, 28
    s_cselect_b32 s14, 0, s14
    s_lshl_b32 s13, s14, 14
    s_add_u32 m0, s84, 0
    s_add_u32 s13, s13, s8
    buffer_load_dwordx4 v14, s[44:47], s13 offen offset:0 lds
    buffer_load_dwordx4 v15, s[44:47], s13 offen offset:1024 lds
    s_waitcnt vmcnt(8)
    s_waitcnt lgkmcnt(0)
    v_mfma_f32_16x16x32_bf16 v[16:19], v[80:83], v[96:99], v[16:19]
    s_nop 3
    v_mfma_f32_16x16x32_bf16 v[20:23], v[80:83], v[100:103], v[20:23]
    s_add_u32 s14, s14, 1
    s_cmp_eq_u32 s14, 28
    s_cselect_b32 s14, 0, s14
    s_lshl_b32 s13, s14, 14
    s_add_u32 m0, s84, 2048
    s_add_u32 s13, s13, s8
    buffer_load_dwordx4 v14, s[44:47], s13 offen offset:0 lds
    buffer_load_dwordx4 v15, s[44:47], s13 offen offset:1024 lds
    s_nop 3
    v_mfma_f32_16x16x32_bf16 v[32:35], v[84:87], v[96:99], 0
    s_nop 3
    v_mfma_f32_16x16x32_bf16 v[36:39], v[84:87], v[100:103], 0
    s_add_u32 s13, s15, s11
    buffer_load_dwordx4 v[120:123], v153, s[40:43], s13 offen offset:0
    buffer_load_dwordx4 v[124:127], v153, s[40:43], s13 offen offset:256
    s_nop 3
    v_mfma_f32_16x16x32_bf16 v[48:51], v[88:91], v[96:99], 0
    s_nop 3
    v_mfma_f32_16x16x32_bf16 v[52:55], v[88:91], v[100:103], 0
    s_waitcnt vmcnt(10)
    ds_read_b64_tr_b16 v[144:145], v8 offset:4096
    ds_read_b64_tr_b16 v[148:149], v9 offset:4096
    ds_read_b64_tr_b16 v[160:161], v10 offset:4096
    ds_read_b64_tr_b16 v[164:165], v11 offset:4096
    s_nop 3
    v_mfma_f32_16x16x32_bf16 v[64:67], v[92:95], v[96:99], 0
    s_nop 3
    v_mfma_f32_16x16x32_bf16 v[68:71], v[92:95], v[100:103], 0
    s_waitcnt vmcnt(8)
    s_waitcnt lgkmcnt(0)
    v_mfma_f32_16x16x32_bf16 v[24:27], v[80:83], v[104:107], v[24:27]
    s_nop 3
    v_mfma_f32_16x16x32_bf16 v[28:31], v[80:83], v[108:111], v[28:31]
    s_add_u32 s14, s14, 1
    s_cmp_eq_u32 s14, 28
    s_cselect_b32 s14, 0, s14
    s_lshl_b32 s13, s14, 14
    s_add_u32 m0, s84, 4096
    s_add_u32 s13, s13, s8
    buffer_load_dwordx4 v14, s[44:47], s13 offen offset:0 lds
    buffer_load_dwordx4 v15, s[44:47], s13 offen offset:1024 lds
    s_nop 3
    v_mfma_f32_16x16x32_bf16 v[40:43], v[84:87], v[104:107], 0
    s_nop 3
    v_mfma_f32_16x16x32_bf16 v[44:47], v[84:87], v[108:111], 0
    s_add_u32 s15, s15, 2048
    s_cmp_eq_u32 s15, 28672
    s_cselect_b32 s15, 0, s15
    s_add_u32 s13, s15, s10
    buffer_load_dwordx4 v[96:99], v153, s[40:43], s13 offen offset:0
    buffer_load_dwordx4 v[100:103], v153, s[40:43], s13 offen offset:256
    s_nop 3
    v_mfma_f32_16x16x32_bf16 v[56:59], v[88:91], v[104:107], 0
    s_nop 3
    v_mfma_f32_16x16x32_bf16 v[60:63], v[88:91], v[108:111], 0
    s_waitcnt vmcnt(8)
    ds_read_b64_tr_b16 v[146:147], v8 offset:0
    ds_read_b64_tr_b16 v[150:151], v9 offset:0
    ds_read_b64_tr_b16 v[162:163], v10 offset:0
    ds_read_b64_tr_b16 v[166:167], v11 offset:0
    s_nop 3
    v_mfma_f32_16x16x32_bf16 v[72:75], v[92:95], v[104:107], 0
    s_nop 3
    v_mfma_f32_16x16x32_bf16 v[76:79], v[92:95], v[108:111], 0
    s_waitcnt vmcnt(10)
    s_waitcnt lgkmcnt(0)
    v_mfma_f32_16x16x32_bf16 v[16:19], v[144:147], v[112:115], v[16:19]
    s_nop 3
    v_mfma_f32_16x16x32_bf16 v[20:23], v[144:147], v[116:119], v[20:23]
    s_add_u32 s14, s14, 1
    s_cmp_eq_u32 s14, 28
    s_cselect_b32 s14, 0, s14
    s_lshl_b32 s13, s14, 14
    s_add_u32 m0, s84, 0
    s_add_u32 s13, s13, s8
    buffer_load_dwordx4 v14, s[44:47], s13 offen offset:0 lds
    buffer_load_dwordx4 v15, s[44:47], s13 offen offset:1024 lds
    s_nop 3
    v_mfma_f32_16x16x32_bf16 v[32:35], v[148:151], v[112:115], v[32:35]
    s_nop 3
    v_mfma_f32_16x16x32_bf16 v[36:39], v[148:151], v[116:119], v[36:39]
    s_add_u32 s13, s15, s11
    buffer_load_dwordx4 v[104:107], v153, s[40:43], s13 offen offset:0
    buffer_load_dwordx4 v[108:111], v153, s[40:43], s13 offen offset:256
    s_nop 3
    v_mfma_f32_16x16x32_bf16 v[48:51], v[160:163], v[112:115], v[48:51]
    s_nop 3
    v_mfma_f32_16x16x32_bf16 v[52:55], v[160:163], v[116:119], v[52:55]
    s_waitcnt vmcnt(10)
    ds_read_b64_tr_b16 v[80:81], v8 offset:2048
    ds_read_b64_tr_b16 v[84:85], v9 offset:2048
    ds_read_b64_tr_b16 v[88:89], v10 offset:2048
    ds_read_b64_tr_b16 v[92:93], v11 offset:2048
    s_nop 3
    v_mfma_f32_16x16x32_bf16 v[64:67], v[164:167], v[112:115], v[64:67]
    s_nop 3
    v_mfma_f32_16x16x32_bf16 v[68:71], v[164:167], v[116:119], v[68:71]
    s_waitcnt vmcnt(8)
    s_waitcnt lgkmcnt(0)
    v_mfma_f32_16x16x32_bf16 v[24:27], v[144:147], v[120:123], v[24:27]
    s_nop 3
    v_mfma_f32_16x16x32_bf16 v[28:31], v[144:147], v[124:127], v[28:31]
    s_add_u32 s14, s14, 1
    s_cmp_eq_u32 s14, 28
    s_cselect_b32 s14, 0, s14
    s_lshl_b32 s13, s14, 14
    s_add_u32 m0, s84, 2048
    s_add_u32 s13, s13, s8
    buffer_load_dwordx4 v14, s[44:47], s13 offen offset:0 lds
    buffer_load_dwordx4 v15, s[44:47], s13 offen offset:1024 lds
    s_nop 3
    v_mfma_f32_16x16x32_bf16 v[40:43], v[148:151], v[120:123], v[40:43]
    s_nop 3
    v_mfma_f32_16x16x32_bf16 v[44:47], v[148:151], v[124:127], v[44:47]
    s_add_u32 s15, s15, 2048
    s_cmp_eq_u32 s15, 28672
    s_cselect_b32 s15, 0, s15
    s_add_u32 s13, s15, s10
    buffer_load_dwordx4 v[112:115], v153, s[40:43], s13 offen offset:0
    buffer_load_dwordx4 v[116:119], v153, s[40:43], s13 offen offset:256
    s_nop 3
    v_mfma_f32_16x16x32_bf16 v[56:59], v[160:163], v[120:123], v[56:59]
    s_nop 3
    v_mfma_f32_16x16x32_bf16 v[60:63], v[160:163], v[124:127], v[60:63]
    s_waitcnt vmcnt(10)
    ds_read_b64_tr_b16 v[82:83], v8 offset:4096
    ds_read_b64_tr_b16 v[86:87], v9 offset:4096
    ds_read_b64_tr_b16 v[90:91], v10 offset:4096
    ds_read_b64_tr_b16 v[94:95], v11 offset:4096
    s_nop 3
    v_mfma_f32_16x16x32_bf16 v[72:75], v[164:167], v[120:123], v[72:75]
    s_nop 3
    v_mfma_f32_16x16x32_bf16 v[76:79], v[164:167], v[124:127], v[76:79]
    s_waitcnt vmcnt(8)
    s_waitcnt lgkmcnt(0)
    v_mfma_f32_16x16x32_bf16 v[16:19], v[80:83], v[96:99], v[16:19]
    s_nop 3
    v_mfma_f32_16x16x32_bf16 v[20:23], v[80:83], v[100:103], v[20:23]
    s_add_u32 s14, s14, 1
    s_cmp_eq_u32 s14, 28
    s_cselect_b32 s14, 0, s14
    s_lshl_b32 s13, s14, 14
    s_add_u32 m0, s84, 4096
    s_add_u32 s13, s13, s8
    buffer_load_dwordx4 v14, s[44:47], s13 offen offset:0 lds
    buffer_load_dwordx4 v15, s[44:47], s13 offen offset:1024 lds
    s_nop 3
    v_mfma_f32_16x16x32_bf16 v[32:35], v[84:87], v[96:99], v[32:35]
    s_nop 3
    v_mfma_f32_16x16x32_bf16 v[36:39], v[84:87], v[100:103], v[36:39]
    s_add_u32 s13, s15, s11
    buffer_load_dwordx4 v[120:123], v153, s[40:43], s13 offen offset:0
    buffer_load_dwordx4 v[124:127], v153, s[40:43], s13 offen offset:256
    s_nop 3
    v_mfma_f32_16x16x32_bf16 v[48:51], v[88:91], v[96:99], v[48:51]
    s_nop 3
    v_mfma_f32_16x16x32_bf16 v[52:55], v[88:91], v[100:103], v[52:55]
    s_waitcnt vmcnt(10)
    ds_read_b64_tr_b16 v[144:145], v8 offset:0
    ds_read_b64_tr_b16 v[148:149], v9 offset:0
    ds_read_b64_tr_b16 v[160:161], v10 offset:0
    ds_read_b64_tr_b16 v[164:165], v11 offset:0
    s_nop 3
    v_mfma_f32_16x16x32_bf16 v[64:67], v[92:95], v[96:99], v[64:67]
    s_nop 3
    v_mfma_f32_16x16x32_bf16 v[68:71], v[92:95], v[100:103], v[68:71]
    s_waitcnt vmcnt(8)
    s_waitcnt lgkmcnt(0)
    v_mfma_f32_16x16x32_bf16 v[24:27], v[80:83], v[104:107], v[24:27]
    s_nop 3
    v_mfma_f32_16x16x32_bf16 v[28:31], v[80:83], v[108:111], v[28:31]
    s_add_u32 s14, s14, 1
    s_cmp_eq_u32 s14, 28
    s_cselect_b32 s14, 0, s14
    s_lshl_b32 s13, s14, 14
    s_add_u32 m0, s84, 0
    s_add_u32 s13, s13, s8
    buffer_load_dwordx4 v14, s[44:47], s13 offen offset:0 lds
    buffer_load_dwordx4 v15, s[44:47], s13 offen offset:1024 lds
    s_nop 3
    v_mfma_f32_16x16x32_bf16 v[40:43], v[84:87], v[104:107], v[40:43]
    s_nop 3
    v_mfma_f32_16x16x32_bf16 v[44:47], v[84:87], v[108:111], v[44:47]
    s_add_u32 s15, s15, 2048
    s_cmp_eq_u32 s15, 28672
    s_cselect_b32 s15, 0, s15
    s_add_u32 s13, s15, s10
    buffer_load_dwordx4 v[96:99], v153, s[40:43], s13 offen offset:0
    buffer_load_dwordx4 v[100:103], v153, s[40:43], s13 offen offset:256
    s_nop 3
    v_mfma_f32_16x16x32_bf16 v[56:59], v[88:91], v[104:107], v[56:59]
    s_nop 3
    v_mfma_f32_16x16x32_bf16 v[60:63], v[88:91], v[108:111], v[60:63]
    s_waitcnt vmcnt(10)
    ds_read_b64_tr_b16 v[146:147], v8 offset:2048
    ds_read_b64_tr_b16 v[150:151], v9 offset:2048
    ds_read_b64_tr_b16 v[162:163], v10 offset:2048
    ds_read_b64_tr_b16 v[166:167], v11 offset:2048
    s_nop 3
    v_mfma_f32_16x16x32_bf16 v[72:75], v[92:95], v[104:107], v[72:75]
    s_nop 3
    v_mfma_f32_16x16x32_bf16 v[76:79], v[92:95], v[108:111], v[76:79]
    s_waitcnt vmcnt(8)
    s_waitcnt lgkmcnt(0)
    v_mfma_f32_16x16x32_bf16 v[16:19], v[144:147], v[112:115], v[16:19]
    s_nop 3
    v_mfma_f32_16x16x32_bf16 v[20:23], v[144:147], v[116:119], v[20:23]
    s_add_u32 s14, s14, 1
    s_cmp_eq_u32 s14, 28
    s_cselect_b32 s14, 0, s14
    s_lshl_b32 s13, s14, 14
    s_add_u32 m0, s84, 2048
    s_add_u32 s13, s13, s8
    buffer_load_dwordx4 v14, s[44:47], s13 offen offset:0 lds
    buffer_load_dwordx4 v15, s[44:47], s13 offen offset:1024 lds
    s_nop 3
    v_mfma_f32_16x16x32_bf16 v[32:35], v[148:151], v[112:115], v[32:35]
    s_nop 3
    v_mfma_f32_16x16x32_bf16 v[36:39], v[148:151], v[116:119], v[36:39]
    s_add_u32 s13, s15, s11
    buffer_load_dwordx4 v[104:107], v153, s[40:43], s13 offen offset:0
    buffer_load_dwordx4 v[108:111], v153, s[40:43], s13 offen offset:256
    s_nop 3
    v_mfma_f32_16x16x32_bf16 v[48:51], v[160:163], v[112:115], v[48:51]
    s_nop 3
    v_mfma_f32_16x16x32_bf16 v[52:55], v[160:163], v[116:119], v[52:55]
    s_waitcnt vmcnt(10)
    ds_read_b64_tr_b16 v[80:81], v8 offset:4096
    ds_read_b64_tr_b16 v[84:85], v9 offset:4096
    ds_read_b64_tr_b16 v[88:89], v10 offset:4096
    ds_read_b64_tr_b16 v[92:93], v11 offset:4096
    s_nop 3
    v_mfma_f32_16x16x32_bf16 v[64:67], v[164:167], v[112:115], v[64:67]
    s_nop 3
    v_mfma_f32_16x16x32_bf16 v[68:71], v[164:167], v[116:119], v[68:71]
    s_waitcnt vmcnt(8)
    s_waitcnt lgkmcnt(0)
    v_mfma_f32_16x16x32_bf16 v[24:27], v[144:147], v[120:123], v[24:27]
    s_nop 3
    v_mfma_f32_16x16x32_bf16 v[28:31], v[144:147], v[124:127], v[28:31]
    s_add_u32 s14, s14, 1
    s_cmp_eq_u32 s14, 28
    s_cselect_b32 s14, 0, s14
    s_lshl_b32 s13, s14, 14
    s_add_u32 m0, s84, 4096
    s_add_u32 s13, s13, s8
    buffer_load_dwordx4 v14, s[44:47], s13 offen offset:0 lds
    buffer_load_dwordx4 v15, s[44:47], s13 offen offset:1024 lds
    s_nop 3
    v_mfma_f32_16x16x32_bf16 v[40:43], v[148:151], v[120:123], v[40:43]
    s_nop 3
    v_mfma_f32_16x16x32_bf16 v[44:47], v[148:151], v[124:127], v[44:47]
    s_add_u32 s15, s15, 2048
    s_cmp_eq_u32 s15, 28672
    s_cselect_b32 s15, 0, s15
    s_add_u32 s13, s15, s10
    buffer_load_dwordx4 v[112:115], v153, s[40:43], s13 offen offset:0
    buffer_load_dwordx4 v[116:119], v153, s[40:43], s13 offen offset:256
    s_nop 3
    v_mfma_f32_16x16x32_bf16 v[56:59], v[160:163], v[120:123], v[56:59]
    s_nop 3
    v_mfma_f32_16x16x32_bf16 v[60:63], v[160:163], v[124:127], v[60:63]
    s_waitcnt vmcnt(10)
    ds_read_b64_tr_b16 v[82:83], v8 offset:0
    ds_read_b64_tr_b16 v[86:87], v9 offset:0
    ds_read_b64_tr_b16 v[90:91], v10 offset:0
    ds_read_b64_tr_b16 v[94:95], v11 offset:0
    s_nop 3
    v_mfma_f32_16x16x32_bf16 v[72:75], v[164:167], v[120:123], v[72:75]
    s_nop 3
    v_mfma_f32_16x16x32_bf16 v[76:79], v[164:167], v[124:127], v[76:79]
    s_waitcnt vmcnt(8)
    s_waitcnt lgkmcnt(0)
    v_mfma_f32_16x16x32_bf16 v[16:19], v[80:83], v[96:99], v[16:19]
    s_nop 3
    v_mfma_f32_16x16x32_bf16 v[20:23], v[80:83], v[100:103], v[20:23]
    s_add_u32 s14, s14, 1
    s_cmp_eq_u32 s14, 28
    s_cselect_b32 s14, 0, s14
    s_lshl_b32 s13, s14, 14
    s_add_u32 m0, s84, 0
    s_add_u32 s13, s13, s8
    buffer_load_dwordx4 v14, s[44:47], s13 offen offset:0 lds
    buffer_load_dwordx4 v15, s[44:47], s13 offen offset:1024 lds
    s_nop 3
    v_mfma_f32_16x16x32_bf16 v[32:35], v[84:87], v[96:99], v[32:35]
    s_nop 3
    v_mfma_f32_16x16x32_bf16 v[36:39], v[84:87], v[100:103], v[36:39]
    s_add_u32 s13, s15, s11
    buffer_load_dwordx4 v[120:123], v153, s[40:43], s13 offen offset:0
    buffer_load_dwordx4 v[124:127], v153, s[40:43], s13 offen offset:256
    s_nop 3
    v_mfma_f32_16x16x32_bf16 v[48:51], v[88:91], v[96:99], v[48:51]
    s_nop 3
    v_mfma_f32_16x16x32_bf16 v[52:55], v[88:91], v[100:103], v[52:55]
    s_waitcnt vmcnt(10)
    ds_read_b64_tr_b16 v[144:145], v8 offset:2048
    ds_read_b64_tr_b16 v[148:149], v9 offset:2048
    ds_read_b64_tr_b16 v[160:161], v10 offset:2048
    ds_read_b64_tr_b16 v[164:165], v11 offset:2048
    s_nop 3
    v_mfma_f32_16x16x32_bf16 v[64:67], v[92:95], v[96:99], v[64:67]
    s_nop 3
    v_mfma_f32_16x16x32_bf16 v[68:71], v[92:95], v[100:103], v[68:71]
    s_waitcnt vmcnt(8)
    s_waitcnt lgkmcnt(0)
    v_mfma_f32_16x16x32_bf16 v[24:27], v[80:83], v[104:107], v[24:27]
    s_nop 3
    v_mfma_f32_16x16x32_bf16 v[28:31], v[80:83], v[108:111], v[28:31]
    s_add_u32 s14, s14, 1
    s_cmp_eq_u32 s14, 28
    s_cselect_b32 s14, 0, s14
    s_lshl_b32 s13, s14, 14
    s_add_u32 m0, s84, 2048
    s_add_u32 s13, s13, s8
    buffer_load_dwordx4 v14, s[44:47], s13 offen offset:0 lds
    buffer_load_dwordx4 v15, s[44:47], s13 offen offset:1024 lds
    s_nop 3
    v_mfma_f32_16x16x32_bf16 v[40:43], v[84:87], v[104:107], v[40:43]
    s_nop 3
    v_mfma_f32_16x16x32_bf16 v[44:47], v[84:87], v[108:111], v[44:47]
    s_add_u32 s15, s15, 2048
    s_cmp_eq_u32 s15, 28672
    s_cselect_b32 s15, 0, s15
    s_add_u32 s13, s15, s10
    buffer_load_dwordx4 v[96:99], v153, s[40:43], s13 offen offset:0
    buffer_load_dwordx4 v[100:103], v153, s[40:43], s13 offen offset:256
    s_nop 3
    v_mfma_f32_16x16x32_bf16 v[56:59], v[88:91], v[104:107], v[56:59]
    s_nop 3
    v_mfma_f32_16x16x32_bf16 v[60:63], v[88:91], v[108:111], v[60:63]
    s_waitcnt vmcnt(10)
    ds_read_b64_tr_b16 v[146:147], v8 offset:4096
    ds_read_b64_tr_b16 v[150:151], v9 offset:4096
    ds_read_b64_tr_b16 v[162:163], v10 offset:4096
    ds_read_b64_tr_b16 v[166:167], v11 offset:4096
    s_nop 3
    v_mfma_f32_16x16x32_bf16 v[72:75], v[92:95], v[104:107], v[72:75]
    s_nop 3
    v_mfma_f32_16x16x32_bf16 v[76:79], v[92:95], v[108:111], v[76:79]
    s_waitcnt vmcnt(8)
    s_waitcnt lgkmcnt(0)
    v_mfma_f32_16x16x32_bf16 v[16:19], v[144:147], v[112:115], v[16:19]
    s_nop 3
    v_mfma_f32_16x16x32_bf16 v[20:23], v[144:147], v[116:119], v[20:23]
    s_add_u32 s14, s14, 1
    s_cmp_eq_u32 s14, 28
    s_cselect_b32 s14, 0, s14
    s_lshl_b32 s13, s14, 14
    s_add_u32 m0, s84, 4096
    s_add_u32 s13, s13, s8
    buffer_load_dwordx4 v14, s[44:47], s13 offen offset:0 lds
    buffer_load_dwordx4 v15, s[44:47], s13 offen offset:1024 lds
    s_nop 3
    v_mfma_f32_16x16x32_bf16 v[32:35], v[148:151], v[112:115], v[32:35]
    s_nop 3
    v_mfma_f32_16x16x32_bf16 v[36:39], v[148:151], v[116:119], v[36:39]
    s_add_u32 s13, s15, s11
    buffer_load_dwordx4 v[104:107], v153, s[40:43], s13 offen offset:0
    buffer_load_dwordx4 v[108:111], v153, s[40:43], s13 offen offset:256
    s_nop 3
    v_mfma_f32_16x16x32_bf16 v[48:51], v[160:163], v[112:115], v[48:51]
    s_nop 3
    v_mfma_f32_16x16x32_bf16 v[52:55], v[160:163], v[116:119], v[52:55]
    s_waitcnt vmcnt(10)
    ds_read_b64_tr_b16 v[80:81], v8 offset:0
    ds_read_b64_tr_b16 v[84:85], v9 offset:0
    ds_read_b64_tr_b16 v[88:89], v10 offset:0
    ds_read_b64_tr_b16 v[92:93], v11 offset:0
    s_nop 3
    v_mfma_f32_16x16x32_bf16 v[64:67], v[164:167], v[112:115], v[64:67]
    s_nop 3
    v_mfma_f32_16x16x32_bf16 v[68:71], v[164:167], v[116:119], v[68:71]
    s_waitcnt vmcnt(8)
    s_waitcnt lgkmcnt(0)
    v_mfma_f32_16x16x32_bf16 v[24:27], v[144:147], v[120:123], v[24:27]
    s_nop 3
    v_mfma_f32_16x16x32_bf16 v[28:31], v[144:147], v[124:127], v[28:31]
    s_add_u32 s14, s14, 1
    s_cmp_eq_u32 s14, 28
    s_cselect_b32 s14, 0, s14
    s_lshl_b32 s13, s14, 14
    s_add_u32 m0, s84, 0
    s_add_u32 s13, s13, s8
    buffer_load_dwordx4 v14, s[44:47], s13 offen offset:0 lds
    buffer_load_dwordx4 v15, s[44:47], s13 offen offset:1024 lds
    s_nop 3
    v_mfma_f32_16x16x32_bf16 v[40:43], v[148:151], v[120:123], v[40:43]
    s_nop 3
    v_mfma_f32_16x16x32_bf16 v[44:47], v[148:151], v[124:127], v[44:47]
    s_add_u32 s15, s15, 2048
    s_cmp_eq_u32 s15, 28672
    s_cselect_b32 s15, 0, s15
    s_add_u32 s13, s15, s10
    buffer_load_dwordx4 v[112:115], v153, s[40:43], s13 offen offset:0
    buffer_load_dwordx4 v[116:119], v153, s[40:43], s13 offen offset:256
    s_nop 3
    v_mfma_f32_16x16x32_bf16 v[56:59], v[160:163], v[120:123], v[56:59]
    s_nop 3
    v_mfma_f32_16x16x32_bf16 v[60:63], v[160:163], v[124:127], v[60:63]
    s_waitcnt vmcnt(10)
    ds_read_b64_tr_b16 v[82:83], v8 offset:2048
    ds_read_b64_tr_b16 v[86:87], v9 offset:2048
    ds_read_b64_tr_b16 v[90:91], v10 offset:2048
    ds_read_b64_tr_b16 v[94:95], v11 offset:2048
    s_nop 3
    v_mfma_f32_16x16x32_bf16 v[72:75], v[164:167], v[120:123], v[72:75]
    s_nop 3
    v_mfma_f32_16x16x32_bf16 v[76:79], v[164:167], v[124:127], v[76:79]
    s_waitcnt vmcnt(8)
    s_waitcnt lgkmcnt(0)
    v_mfma_f32_16x16x32_bf16 v[16:19], v[80:83], v[96:99], v[16:19]
    s_nop 3
    v_mfma_f32_16x16x32_bf16 v[20:23], v[80:83], v[100:103], v[20:23]
    s_add_u32 s14, s14, 1
    s_cmp_eq_u32 s14, 28
    s_cselect_b32 s14, 0, s14
    s_lshl_b32 s13, s14, 14
    s_add_u32 m0, s84, 2048
    s_add_u32 s13, s13, s8
    buffer_load_dwordx4 v14, s[44:47], s13 offen offset:0 lds
    buffer_load_dwordx4 v15, s[44:47], s13 offen offset:1024 lds
    s_nop 3
    v_mfma_f32_16x16x32_bf16 v[32:35], v[84:87], v[96:99], v[32:35]
    s_nop 3
    v_mfma_f32_16x16x32_bf16 v[36:39], v[84:87], v[100:103], v[36:39]
    s_add_u32 s13, s15, s11
    buffer_load_dwordx4 v[120:123], v153, s[40:43], s13 offen offset:0
    buffer_load_dwordx4 v[124:127], v153, s[40:43], s13 offen offset:256
    s_nop 3
    v_mfma_f32_16x16x32_bf16 v[48:51], v[88:91], v[96:99], v[48:51]
    s_nop 3
    v_mfma_f32_16x16x32_bf16 v[52:55], v[88:91], v[100:103], v[52:55]
    s_waitcnt vmcnt(10)
    ds_read_b64_tr_b16 v[144:145], v8 offset:4096
    ds_read_b64_tr_b16 v[148:149], v9 offset:4096
    ds_read_b64_tr_b16 v[160:161], v10 offset:4096
    ds_read_b64_tr_b16 v[164:165], v11 offset:4096
    s_nop 3
    v_mfma_f32_16x16x32_bf16 v[64:67], v[92:95], v[96:99], v[64:67]
    s_nop 3
    v_mfma_f32_16x16x32_bf16 v[68:71], v[92:95], v[100:103], v[68:71]
    s_waitcnt vmcnt(8)
    s_waitcnt lgkmcnt(0)
    v_mfma_f32_16x16x32_bf16 v[24:27], v[80:83], v[104:107], v[24:27]
    s_nop 3
    v_mfma_f32_16x16x32_bf16 v[28:31], v[80:83], v[108:111], v[28:31]
    s_add_u32 s14, s14, 1
    s_cmp_eq_u32 s14, 28
    s_cselect_b32 s14, 0, s14
    s_lshl_b32 s13, s14, 14
    s_add_u32 m0, s84, 4096
    s_add_u32 s13, s13, s8
    buffer_load_dwordx4 v14, s[44:47], s13 offen offset:0 lds
    buffer_load_dwordx4 v15, s[44:47], s13 offen offset:1024 lds
    s_nop 3
    v_mfma_f32_16x16x32_bf16 v[40:43], v[84:87], v[104:107], v[40:43]
    s_nop 3
    v_mfma_f32_16x16x32_bf16 v[44:47], v[84:87], v[108:111], v[44:47]
    s_add_u32 s15, s15, 2048
    s_cmp_eq_u32 s15, 28672
    s_cselect_b32 s15, 0, s15
    s_add_u32 s13, s15, s10
    buffer_load_dwordx4 v[96:99], v153, s[40:43], s13 offen offset:0
    buffer_load_dwordx4 v[100:103], v153, s[40:43], s13 offen offset:256
    s_nop 3
    v_mfma_f32_16x16x32_bf16 v[56:59], v[88:91], v[104:107], v[56:59]
    s_nop 3
    v_mfma_f32_16x16x32_bf16 v[60:63], v[88:91], v[108:111], v[60:63]
    s_waitcnt vmcnt(10)
    ds_read_b64_tr_b16 v[146:147], v8 offset:0
    ds_read_b64_tr_b16 v[150:151], v9 offset:0
    ds_read_b64_tr_b16 v[162:163], v10 offset:0
    ds_read_b64_tr_b16 v[166:167], v11 offset:0
    s_nop 3
    v_mfma_f32_16x16x32_bf16 v[72:75], v[92:95], v[104:107], v[72:75]
    s_nop 3
    v_mfma_f32_16x16x32_bf16 v[76:79], v[92:95], v[108:111], v[76:79]
    s_waitcnt vmcnt(8)
    s_waitcnt lgkmcnt(0)
    v_mfma_f32_16x16x32_bf16 v[16:19], v[144:147], v[112:115], v[16:19]
    s_nop 3
    v_mfma_f32_16x16x32_bf16 v[20:23], v[144:147], v[116:119], v[20:23]
    s_add_u32 s14, s14, 1
    s_cmp_eq_u32 s14, 28
    s_cselect_b32 s14, 0, s14
    s_lshl_b32 s13, s14, 14
    s_add_u32 m0, s84, 0
    s_add_u32 s13, s13, s8
    buffer_load_dwordx4 v14, s[44:47], s13 offen offset:0 lds
    buffer_load_dwordx4 v15, s[44:47], s13 offen offset:1024 lds
    s_nop 3
    v_mfma_f32_16x16x32_bf16 v[32:35], v[148:151], v[112:115], v[32:35]
    s_nop 3
    v_mfma_f32_16x16x32_bf16 v[36:39], v[148:151], v[116:119], v[36:39]
    s_add_u32 s13, s15, s11
    buffer_load_dwordx4 v[104:107], v153, s[40:43], s13 offen offset:0
    buffer_load_dwordx4 v[108:111], v153, s[40:43], s13 offen offset:256
    s_nop 3
    v_mfma_f32_16x16x32_bf16 v[48:51], v[160:163], v[112:115], v[48:51]
    s_nop 3
    v_mfma_f32_16x16x32_bf16 v[52:55], v[160:163], v[116:119], v[52:55]
    s_waitcnt vmcnt(10)
    ds_read_b64_tr_b16 v[80:81], v8 offset:2048
    ds_read_b64_tr_b16 v[84:85], v9 offset:2048
    ds_read_b64_tr_b16 v[88:89], v10 offset:2048
    ds_read_b64_tr_b16 v[92:93], v11 offset:2048
    s_nop 3
    v_mfma_f32_16x16x32_bf16 v[64:67], v[164:167], v[112:115], v[64:67]
    s_nop 3
    v_mfma_f32_16x16x32_bf16 v[68:71], v[164:167], v[116:119], v[68:71]
    s_waitcnt vmcnt(8)
    s_waitcnt lgkmcnt(0)
    v_mfma_f32_16x16x32_bf16 v[24:27], v[144:147], v[120:123], v[24:27]
    s_nop 3
    v_mfma_f32_16x16x32_bf16 v[28:31], v[144:147], v[124:127], v[28:31]
    s_add_u32 s14, s14, 1
    s_cmp_eq_u32 s14, 28
    s_cselect_b32 s14, 0, s14
    s_lshl_b32 s13, s14, 14
    s_add_u32 m0, s84, 2048
    s_add_u32 s13, s13, s8
    buffer_load_dwordx4 v14, s[44:47], s13 offen offset:0 lds
    buffer_load_dwordx4 v15, s[44:47], s13 offen offset:1024 lds
    s_nop 3
    v_mfma_f32_16x16x32_bf16 v[40:43], v[148:151], v[120:123], v[40:43]
    s_nop 3
    v_mfma_f32_16x16x32_bf16 v[44:47], v[148:151], v[124:127], v[44:47]
    s_add_u32 s15, s15, 2048
    s_cmp_eq_u32 s15, 28672
    s_cselect_b32 s15, 0, s15
    s_add_u32 s13, s15, s10
    buffer_load_dwordx4 v[112:115], v153, s[40:43], s13 offen offset:0
    buffer_load_dwordx4 v[116:119], v153, s[40:43], s13 offen offset:256
    s_nop 3
    v_mfma_f32_16x16x32_bf16 v[56:59], v[160:163], v[120:123], v[56:59]
    s_nop 3
    v_mfma_f32_16x16x32_bf16 v[60:63], v[160:163], v[124:127], v[60:63]
    s_waitcnt vmcnt(10)
    ds_read_b64_tr_b16 v[82:83], v8 offset:4096
    ds_read_b64_tr_b16 v[86:87], v9 offset:4096
    ds_read_b64_tr_b16 v[90:91], v10 offset:4096
    ds_read_b64_tr_b16 v[94:95], v11 offset:4096
    s_nop 3
    v_mfma_f32_16x16x32_bf16 v[72:75], v[164:167], v[120:123], v[72:75]
    s_nop 3
    v_mfma_f32_16x16x32_bf16 v[76:79], v[164:167], v[124:127], v[76:79]
    s_waitcnt vmcnt(8)
    s_waitcnt lgkmcnt(0)
    v_mfma_f32_16x16x32_bf16 v[16:19], v[80:83], v[96:99], v[16:19]
    s_nop 3
    v_mfma_f32_16x16x32_bf16 v[20:23], v[80:83], v[100:103], v[20:23]
    s_add_u32 s14, s14, 1
    s_cmp_eq_u32 s14, 28
    s_cselect_b32 s14, 0, s14
    s_lshl_b32 s13, s14, 14
    s_add_u32 m0, s84, 4096
    s_add_u32 s13, s13, s8
    buffer_load_dwordx4 v14, s[44:47], s13 offen offset:0 lds
    buffer_load_dwordx4 v15, s[44:47], s13 offen offset:1024 lds
    s_nop 3
    v_mfma_f32_16x16x32_bf16 v[32:35], v[84:87], v[96:99], v[32:35]
    s_nop 3
    v_mfma_f32_16x16x32_bf16 v[36:39], v[84:87], v[100:103], v[36:39]
    s_add_u32 s13, s15, s11
    buffer_load_dwordx4 v[120:123], v153, s[40:43], s13 offen offset:0
    buffer_load_dwordx4 v[124:127], v153, s[40:43], s13 offen offset:256
    s_nop 3
    v_mfma_f32_16x16x32_bf16 v[48:51], v[88:91], v[96:99], v[48:51]
    s_nop 3
    v_mfma_f32_16x16x32_bf16 v[52:55], v[88:91], v[100:103], v[52:55]
    s_waitcnt vmcnt(10)
    ds_read_b64_tr_b16 v[144:145], v8 offset:0
    ds_read_b64_tr_b16 v[148:149], v9 offset:0
    ds_read_b64_tr_b16 v[160:161], v10 offset:0
    ds_read_b64_tr_b16 v[164:165], v11 offset:0
    s_nop 3
    v_mfma_f32_16x16x32_bf16 v[64:67], v[92:95], v[96:99], v[64:67]
    s_nop 3
    v_mfma_f32_16x16x32_bf16 v[68:71], v[92:95], v[100:103], v[68:71]
    s_waitcnt vmcnt(8)
    s_waitcnt lgkmcnt(0)
    v_mfma_f32_16x16x32_bf16 v[24:27], v[80:83], v[104:107], v[24:27]
    s_nop 3
    v_mfma_f32_16x16x32_bf16 v[28:31], v[80:83], v[108:111], v[28:31]
    s_add_u32 s14, s14, 1
    s_cmp_eq_u32 s14, 28
    s_cselect_b32 s14, 0, s14
    s_lshl_b32 s13, s14, 14
    s_add_u32 m0, s84, 0
    s_add_u32 s13, s13, s8
    buffer_load_dwordx4 v14, s[44:47], s13 offen offset:0 lds
    buffer_load_dwordx4 v15, s[44:47], s13 offen offset:1024 lds
    s_nop 3
    v_mfma_f32_16x16x32_bf16 v[40:43], v[84:87], v[104:107], v[40:43]
    s_nop 3
    v_mfma_f32_16x16x32_bf16 v[44:47], v[84:87], v[108:111], v[44:47]
    s_add_u32 s15, s15, 2048
    s_cmp_eq_u32 s15, 28672
    s_cselect_b32 s15, 0, s15
    s_add_u32 s13, s15, s10
    buffer_load_dwordx4 v[96:99], v153, s[40:43], s13 offen offset:0
    buffer_load_dwordx4 v[100:103], v153, s[40:43], s13 offen offset:256
    s_nop 3
    v_mfma_f32_16x16x32_bf16 v[56:59], v[88:91], v[104:107], v[56:59]
    s_nop 3
    v_mfma_f32_16x16x32_bf16 v[60:63], v[88:91], v[108:111], v[60:63]
    s_waitcnt vmcnt(10)
    ds_read_b64_tr_b16 v[146:147], v8 offset:2048
    ds_read_b64_tr_b16 v[150:151], v9 offset:2048
    ds_read_b64_tr_b16 v[162:163], v10 offset:2048
    ds_read_b64_tr_b16 v[166:167], v11 offset:2048
    s_nop 3
    v_mfma_f32_16x16x32_bf16 v[72:75], v[92:95], v[104:107], v[72:75]
    s_nop 3
    v_mfma_f32_16x16x32_bf16 v[76:79], v[92:95], v[108:111], v[76:79]
    s_waitcnt vmcnt(8)
    s_waitcnt lgkmcnt(0)
    buffer_load_dword v155, v131, s[40:43], s12 offen sc1
    v_mfma_f32_16x16x32_bf16 v[16:19], v[144:147], v[112:115], v[16:19]
    s_nop 3
    v_mfma_f32_16x16x32_bf16 v[20:23], v[144:147], v[116:119], v[20:23]
    s_add_u32 s14, s14, 1
    s_cmp_eq_u32 s14, 28
    s_cselect_b32 s14, 0, s14
    s_lshl_b32 s13, s14, 14
    s_add_u32 m0, s84, 2048
    s_add_u32 s13, s13, s8
    buffer_load_dwordx4 v14, s[44:47], s13 offen offset:0 lds
    buffer_load_dwordx4 v15, s[44:47], s13 offen offset:1024 lds
    s_nop 3
    v_mfma_f32_16x16x32_bf16 v[32:35], v[148:151], v[112:115], v[32:35]
    s_nop 3
    v_mfma_f32_16x16x32_bf16 v[36:39], v[148:151], v[116:119], v[36:39]
    s_add_u32 s13, s15, s11
    buffer_load_dwordx4 v[104:107], v153, s[40:43], s13 offen offset:0
    buffer_load_dwordx4 v[108:111], v153, s[40:43], s13 offen offset:256
    s_nop 3
    v_mfma_f32_16x16x32_bf16 v[48:51], v[160:163], v[112:115], v[48:51]
    s_nop 3
    v_mfma_f32_16x16x32_bf16 v[52:55], v[160:163], v[116:119], v[52:55]
    s_waitcnt vmcnt(11)
    ds_read_b64_tr_b16 v[80:81], v8 offset:4096
    ds_read_b64_tr_b16 v[84:85], v9 offset:4096
    ds_read_b64_tr_b16 v[88:89], v10 offset:4096
    ds_read_b64_tr_b16 v[92:93], v11 offset:4096
    s_nop 3
    v_mfma_f32_16x16x32_bf16 v[64:67], v[164:167], v[112:115], v[64:67]
    s_nop 3
    v_mfma_f32_16x16x32_bf16 v[68:71], v[164:167], v[116:119], v[68:71]
    s_waitcnt vmcnt(9)
    s_waitcnt lgkmcnt(0)
    v_mfma_f32_16x16x32_bf16 v[24:27], v[144:147], v[120:123], v[24:27]
    s_nop 3
    v_mfma_f32_16x16x32_bf16 v[28:31], v[144:147], v[124:127], v[28:31]
    s_add_u32 s14, s14, 1
    s_cmp_eq_u32 s14, 28
    s_cselect_b32 s14, 0, s14
    s_lshl_b32 s13, s14, 14
    s_add_u32 m0, s84, 4096
    s_add_u32 s13, s13, s8
    buffer_load_dwordx4 v14, s[44:47], s13 offen offset:0 lds
    buffer_load_dwordx4 v15, s[44:47], s13 offen offset:1024 lds
    s_nop 3
    v_mfma_f32_16x16x32_bf16 v[40:43], v[148:151], v[120:123], v[40:43]
    s_nop 3
    v_mfma_f32_16x16x32_bf16 v[44:47], v[148:151], v[124:127], v[44:47]
    s_add_u32 s15, s15, 2048
    s_cmp_eq_u32 s15, 28672
    s_cselect_b32 s15, 0, s15
    s_add_u32 s13, s15, s10
    buffer_load_dwordx4 v[112:115], v153, s[40:43], s13 offen offset:0
    buffer_load_dwordx4 v[116:119], v153, s[40:43], s13 offen offset:256
    s_nop 3
    v_mfma_f32_16x16x32_bf16 v[56:59], v[160:163], v[120:123], v[56:59]
    s_nop 3
    v_mfma_f32_16x16x32_bf16 v[60:63], v[160:163], v[124:127], v[60:63]
    s_waitcnt vmcnt(11)
    ds_read_b64_tr_b16 v[82:83], v8 offset:0
    ds_read_b64_tr_b16 v[86:87], v9 offset:0
    ds_read_b64_tr_b16 v[90:91], v10 offset:0
    ds_read_b64_tr_b16 v[94:95], v11 offset:0
    s_nop 3
    v_mfma_f32_16x16x32_bf16 v[72:75], v[164:167], v[120:123], v[72:75]
    s_nop 3
    v_mfma_f32_16x16x32_bf16 v[76:79], v[164:167], v[124:127], v[76:79]
    s_waitcnt vmcnt(9)
    s_waitcnt lgkmcnt(0)
    v_mfma_f32_16x16x32_bf16 v[16:19], v[80:83], v[96:99], v[16:19]
    s_nop 3
    v_mfma_f32_16x16x32_bf16 v[20:23], v[80:83], v[100:103], v[20:23]
    s_add_u32 s14, s14, 1
    s_cmp_eq_u32 s14, 28
    s_cselect_b32 s14, 0, s14
    s_lshl_b32 s13, s14, 14
    s_add_u32 m0, s84, 0
    s_add_u32 s13, s13, s8
    buffer_load_dwordx4 v14, s[44:47], s13 offen offset:0 lds
    buffer_load_dwordx4 v15, s[44:47], s13 offen offset:1024 lds
    s_nop 3
    v_mfma_f32_16x16x32_bf16 v[32:35], v[84:87], v[96:99], v[32:35]
    s_nop 3
    v_mfma_f32_16x16x32_bf16 v[36:39], v[84:87], v[100:103], v[36:39]
    s_add_u32 s13, s15, s11
    buffer_load_dwordx4 v[120:123], v153, s[40:43], s13 offen offset:0
    buffer_load_dwordx4 v[124:127], v153, s[40:43], s13 offen offset:256
    s_nop 3
    v_mfma_f32_16x16x32_bf16 v[48:51], v[88:91], v[96:99], v[48:51]
    s_nop 3
    v_mfma_f32_16x16x32_bf16 v[52:55], v[88:91], v[100:103], v[52:55]
    s_waitcnt vmcnt(10)
    ds_read_b64_tr_b16 v[144:145], v8 offset:2048
    ds_read_b64_tr_b16 v[148:149], v9 offset:2048
    ds_read_b64_tr_b16 v[160:161], v10 offset:2048
    ds_read_b64_tr_b16 v[164:165], v11 offset:2048
    s_nop 3
    v_mfma_f32_16x16x32_bf16 v[64:67], v[92:95], v[96:99], v[64:67]
    s_nop 3
    v_mfma_f32_16x16x32_bf16 v[68:71], v[92:95], v[100:103], v[68:71]
    s_waitcnt vmcnt(8)
    s_waitcnt lgkmcnt(0)
    v_mfma_f32_16x16x32_bf16 v[24:27], v[80:83], v[104:107], v[24:27]
    s_nop 3
    v_mfma_f32_16x16x32_bf16 v[28:31], v[80:83], v[108:111], v[28:31]
    s_add_u32 s14, s14, 1
    s_cmp_eq_u32 s14, 28
    s_cselect_b32 s14, 0, s14
    s_lshl_b32 s13, s14, 14
    s_add_u32 m0, s84, 2048
    s_add_u32 s13, s13, s8
    buffer_load_dwordx4 v14, s[44:47], s13 offen offset:0 lds
    buffer_load_dwordx4 v15, s[44:47], s13 offen offset:1024 lds
    s_nop 3
    v_mfma_f32_16x16x32_bf16 v[40:43], v[84:87], v[104:107], v[40:43]
    s_nop 3
    v_mfma_f32_16x16x32_bf16 v[44:47], v[84:87], v[108:111], v[44:47]
    s_add_u32 s15, s15, 2048
    s_cmp_eq_u32 s15, 28672
    s_cselect_b32 s15, 0, s15
    s_add_u32 s13, s15, s10
    buffer_load_dwordx4 v[96:99], v153, s[40:43], s13 offen offset:0
    buffer_load_dwordx4 v[100:103], v153, s[40:43], s13 offen offset:256
    s_nop 3
    v_mfma_f32_16x16x32_bf16 v[56:59], v[88:91], v[104:107], v[56:59]
    s_nop 3
    v_mfma_f32_16x16x32_bf16 v[60:63], v[88:91], v[108:111], v[60:63]
    s_waitcnt vmcnt(10)
    ds_read_b64_tr_b16 v[146:147], v8 offset:4096
    ds_read_b64_tr_b16 v[150:151], v9 offset:4096
    ds_read_b64_tr_b16 v[162:163], v10 offset:4096
    ds_read_b64_tr_b16 v[166:167], v11 offset:4096
    s_nop 3
    v_mfma_f32_16x16x32_bf16 v[72:75], v[92:95], v[104:107], v[72:75]
    s_nop 3
    v_mfma_f32_16x16x32_bf16 v[76:79], v[92:95], v[108:111], v[76:79]
    s_waitcnt vmcnt(8)
    s_waitcnt lgkmcnt(0)
    v_cmp_ne_u32 vcc, s92, v155
    s_mov_b32 s82, 1
    s_cbranch_vccnz g_gc
    s_mov_b32 s82, 0
    ds_write_b32 v12, v13 offset:24
g_gc:
    v_mfma_f32_16x16x32_bf16 v[16:19], v[144:147], v[112:115], v[16:19]
    s_nop 3
    v_mfma_f32_16x16x32_bf16 v[20:23], v[144:147], v[116:119], v[20:23]
    s_add_u32 s14, s14, 1
    s_cmp_eq_u32 s14, 28
    s_cselect_b32 s14, 0, s14
    s_lshl_b32 s13, s14, 14
    s_add_u32 m0, s84, 4096
    s_add_u32 s13, s13, s8
    buffer_load_dwordx4 v14, s[44:47], s13 offen offset:0 lds
    buffer_load_dwordx4 v15, s[44:47], s13 offen offset:1024 lds
    s_nop 3
    v_mfma_f32_16x16x32_bf16 v[32:35], v[148:151], v[112:115], v[32:35]
    s_nop 3
    v_mfma_f32_16x16x32_bf16 v[36:39], v[148:151], v[116:119], v[36:39]
    s_add_u32 s13, s15, s11
    buffer_load_dwordx4 v[104:107], v153, s[40:43], s13 offen offset:0
    buffer_load_dwordx4 v[108:111], v153, s[40:43], s13 offen offset:256
    s_nop 3
    v_mfma_f32_16x16x32_bf16 v[48:51], v[160:163], v[112:115], v[48:51]
    s_nop 3
    v_mfma_f32_16x16x32_bf16 v[52:55], v[160:163], v[116:119], v[52:55]
    s_waitcnt vmcnt(10)
    ds_read_b64_tr_b16 v[80:81], v8 offset:0
    ds_read_b64_tr_b16 v[84:85], v9 offset:0
    ds_read_b64_tr_b16 v[88:89], v10 offset:0
    ds_read_b64_tr_b16 v[92:93], v11 offset:0
    s_nop 3
    v_mfma_f32_16x16x32_bf16 v[64:67], v[164:167], v[112:115], v[64:67]
    s_nop 3
    v_mfma_f32_16x16x32_bf16 v[68:71], v[164:167], v[116:119], v[68:71]
    s_waitcnt vmcnt(8)
    s_waitcnt lgkmcnt(0)
    v_mfma_f32_16x16x32_bf16 v[24:27], v[144:147], v[120:123], v[24:27]
    s_nop 3
    v_mfma_f32_16x16x32_bf16 v[28:31], v[144:147], v[124:127], v[28:31]
    s_add_u32 s14, s14, 1
    s_cmp_eq_u32 s14, 28
    s_cselect_b32 s14, 0, s14
    s_lshl_b32 s13, s14, 14
    s_add_u32 m0, s84, 0
    s_add_u32 s13, s13, s8
    buffer_load_dwordx4 v14, s[44:47], s13 offen offset:0 lds
    buffer_load_dwordx4 v15, s[44:47], s13 offen offset:1024 lds
    s_nop 3
    v_mfma_f32_16x16x32_bf16 v[40:43], v[148:151], v[120:123], v[40:43]
    s_nop 3
    v_mfma_f32_16x16x32_bf16 v[44:47], v[148:151], v[124:127], v[44:47]
    s_add_u32 s15, s15, 2048
    s_cmp_eq_u32 s15, 28672
    s_cselect_b32 s15, 0, s15
    s_add_u32 s13, s15, s10
    buffer_load_dwordx4 v[112:115], v153, s[40:43], s13 offen offset:0
    buffer_load_dwordx4 v[116:119], v153, s[40:43], s13 offen offset:256
    s_nop 3
    v_mfma_f32_16x16x32_bf16 v[56:59], v[160:163], v[120:123], v[56:59]
    s_nop 3
    v_mfma_f32_16x16x32_bf16 v[60:63], v[160:163], v[124:127], v[60:63]
    s_waitcnt vmcnt(10)
    ds_read_b64_tr_b16 v[82:83], v8 offset:2048
    ds_read_b64_tr_b16 v[86:87], v9 offset:2048
    ds_read_b64_tr_b16 v[90:91], v10 offset:2048
    ds_read_b64_tr_b16 v[94:95], v11 offset:2048
    s_nop 3
    v_mfma_f32_16x16x32_bf16 v[72:75], v[164:167], v[120:123], v[72:75]
    s_nop 3
    v_mfma_f32_16x16x32_bf16 v[76:79], v[164:167], v[124:127], v[76:79]
    s_waitcnt vmcnt(8)
    s_waitcnt lgkmcnt(0)
    v_mfma_f32_16x16x32_bf16 v[16:19], v[80:83], v[96:99], v[16:19]
    s_nop 3
    v_mfma_f32_16x16x32_bf16 v[20:23], v[80:83], v[100:103], v[20:23]
    s_nop 3
    v_mfma_f32_16x16x32_bf16 v[32:35], v[84:87], v[96:99], v[32:35]
    s_nop 3
    v_mfma_f32_16x16x32_bf16 v[36:39], v[84:87], v[100:103], v[36:39]
    s_add_u32 s13, s15, s11
    buffer_load_dwordx4 v[120:123], v153, s[40:43], s13 offen offset:0
    buffer_load_dwordx4 v[124:127], v153, s[40:43], s13 offen offset:256
    s_nop 3
    v_mfma_f32_16x16x32_bf16 v[48:51], v[88:91], v[96:99], v[48:51]
    s_nop 3
    v_mfma_f32_16x16x32_bf16 v[52:55], v[88:91], v[100:103], v[52:55]
    s_waitcnt vmcnt(8)
    ds_read_b64_tr_b16 v[144:145], v8 offset:4096
    ds_read_b64_tr_b16 v[148:149], v9 offset:4096
    ds_read_b64_tr_b16 v[160:161], v10 offset:4096
    ds_read_b64_tr_b16 v[164:165], v11 offset:4096
    s_nop 3
    v_mfma_f32_16x16x32_bf16 v[64:67], v[92:95], v[96:99], v[64:67]
    s_nop 3
    v_mfma_f32_16x16x32_bf16 v[68:71], v[92:95], v[100:103], v[68:71]
    s_waitcnt vmcnt(6)
    s_waitcnt lgkmcnt(0)
    v_mfma_f32_16x16x32_bf16 v[24:27], v[80:83], v[104:107], v[24:27]
    s_nop 3
    v_mfma_f32_16x16x32_bf16 v[28:31], v[80:83], v[108:111], v[28:31]
    s_nop 3
    v_mfma_f32_16x16x32_bf16 v[40:43], v[84:87], v[104:107], v[40:43]
    s_nop 3
    v_mfma_f32_16x16x32_bf16 v[44:47], v[84:87], v[108:111], v[44:47]
    s_nop 3
    v_mfma_f32_16x16x32_bf16 v[56:59], v[88:91], v[104:107], v[56:59]
    s_nop 3
    v_mfma_f32_16x16x32_bf16 v[60:63], v[88:91], v[108:111], v[60:63]
    s_waitcnt vmcnt(4)
    ds_read_b64_tr_b16 v[146:147], v8 offset:0
    ds_read_b64_tr_b16 v[150:151], v9 offset:0
    ds_read_b64_tr_b16 v[162:163], v10 offset:0
    ds_read_b64_tr_b16 v[166:167], v11 offset:0
    s_nop 3
    v_mfma_f32_16x16x32_bf16 v[72:75], v[92:95], v[104:107], v[72:75]
    s_nop 3
    v_mfma_f32_16x16x32_bf16 v[76:79], v[92:95], v[108:111], v[76:79]
    s_waitcnt vmcnt(2)
    s_waitcnt lgkmcnt(0)
    v_mfma_f32_16x16x32_bf16 v[16:19], v[144:147], v[112:115], v[16:19]
    s_nop 3
    v_mfma_f32_16x16x32_bf16 v[20:23], v[144:147], v[116:119], v[20:23]
    s_nop 3
    v_mfma_f32_16x16x32_bf16 v[32:35], v[148:151], v[112:115], v[32:35]
    s_nop 3
    v_mfma_f32_16x16x32_bf16 v[36:39], v[148:151], v[116:119], v[36:39]
    s_nop 3
    v_mfma_f32_16x16x32_bf16 v[48:51], v[160:163], v[112:115], v[48:51]
    s_nop 3
    v_mfma_f32_16x16x32_bf16 v[52:55], v[160:163], v[116:119], v[52:55]
    s_nop 3
    v_mfma_f32_16x16x32_bf16 v[64:67], v[164:167], v[112:115], v[64:67]
    s_nop 3
    v_mfma_f32_16x16x32_bf16 v[68:71], v[164:167], v[116:119], v[68:71]
    s_waitcnt vmcnt(0)
    s_waitcnt lgkmcnt(0)
    v_mfma_f32_16x16x32_bf16 v[24:27], v[144:147], v[120:123], v[24:27]
    s_nop 3
    v_mfma_f32_16x16x32_bf16 v[28:31], v[144:147], v[124:127], v[28:31]
    s_nop 3
    v_mfma_f32_16x16x32_bf16 v[40:43], v[148:151], v[120:123], v[40:43]
    s_nop 3
    v_mfma_f32_16x16x32_bf16 v[44:47], v[148:151], v[124:127], v[44:47]
    s_nop 3
    v_mfma_f32_16x16x32_bf16 v[56:59], v[160:163], v[120:123], v[56:59]
    s_nop 3
    v_mfma_f32_16x16x32_bf16 v[60:63], v[160:163], v[124:127], v[60:63]
    s_nop 3
    v_mfma_f32_16x16x32_bf16 v[72:75], v[164:167], v[120:123], v[72:75]
    s_nop 3
    v_mfma_f32_16x16x32_bf16 v[76:79], v[164:167], v[124:127], v[76:79]
    s_setprio 3
    s_cmp_eq_u32 s82, 0
    s_cbranch_scc1 g_gd
    s_mov_b32 s62, 131072
gp_11:
    buffer_load_dword v137, v131, s[40:43], s12 offen sc1
    s_waitcnt vmcnt(0)
    v_cmp_ne_u32 vcc, s92, v137
    s_cbranch_vccz gpd_12
    s_sleep 4
    s_sub_u32 s62, s62, 1
    s_cmp_lg_u32 s62, 0
    s_cbranch_scc1 gp_11
gpd_12:
    ds_write_b32 v12, v13 offset:24
g_gd:
    s_add_u32 s8, s61, 114688
    s_and_b32 s9, s3, 1
    s_lshl_b32 s9, s9, 8
    s_add_u32 s8, s8, s9
    v_add_f32 v10, 1.0, v152
    v_add_f32 v11, 1.0, v156
    v_add_f32 v14, 1.0, v157
    v_add_f32 v15, 1.0, v159
    s_nop 7
    buffer_load_dwordx4 v[80:83], v153, s[40:43], s8 offen offset:0
    buffer_load_dwordx4 v[84:87], v153, s[40:43], s8 offen offset:2048
    s_add_u32 s8, s8, 4096
    buffer_load_dwordx4 v[88:91], v153, s[40:43], s8 offen offset:0
    buffer_load_dwordx4 v[92:95], v153, s[40:43], s8 offen offset:2048
    s_add_u32 s8, s8, 4096
    buffer_load_dwordx4 v[96:99], v153, s[40:43], s8 offen offset:0
    buffer_load_dwordx4 v[100:103], v153, s[40:43], s8 offen offset:2048
    s_add_u32 s8, s8, 4096
    buffer_load_dwordx4 v[104:107], v153, s[40:43], s8 offen offset:0
    buffer_load_dwordx4 v[108:111], v153, s[40:43], s8 offen offset:2048
    s_add_u32 s8, s8, 4096
    buffer_load_dwordx4 v[112:115], v153, s[40:43], s8 offen offset:0
    buffer_load_dwordx4 v[116:119], v153, s[40:43], s8 offen offset:2048
    s_add_u32 s8, s8, 4096
    buffer_load_dwordx4 v[120:123], v153, s[40:43], s8 offen offset:0
    buffer_load_dwordx4 v[124:127], v153, s[40:43], s8 offen offset:2048
    s_add_u32 s8, s8, 4096
    buffer_load_dwordx4 v[128:131], v153, s[40:43], s8 offen offset:0
    buffer_load_dwordx4 v[132:135], v153, s[40:43], s8 offen offset:2048
    s_add_u32 s8, s8, 4096
    buffer_load_dwordx4 v[136:139], v153, s[40:43], s8 offen offset:0
    buffer_load_dwordx4 v[140:143], v153, s[40:43], s8 offen offset:2048
    s_setprio 0
    s_setprio 0
    ds_write_b128 v4, v[32:35] offset:0
    ds_write_b128 v4, v[36:39] offset:1024
    ds_write_b128 v4, v[40:43] offset:2048
    ds_write_b128 v4, v[44:47] offset:3072
    ds_write_b128 v4, v[64:67] offset:4096
    ds_write_b128 v4, v[68:71] offset:5120
    s_setprio 3
    s_mov_b64 exec, 1
    ds_add_u32 v12, v13 offset:20
    s_mov_b64 exec, -1
    s_waitcnt lgkmcnt(0)
    s_mov_b32 s62, 131072
lp_13:
    ds_read_b32 v8, v12 offset:20
    s_waitcnt lgkmcnt(0)
    v_cmp_gt_u32 vcc, 4, v8
    s_cbranch_vccz lpd_14
    s_sleep 8
    s_sub_u32 s62, s62, 1
    s_cmp_lg_u32 s62, 0
    s_cbranch_scc1 lp_13
lpd_14:
    s_setprio 0
    ds_read_b128 v[144:147], v5 offset:0
    ds_read_b128 v[148:151], v5 offset:1024
    ds_read_b128 v[152:155], v5 offset:2048
    ds_read_b128 v[156:159], v5 offset:3072
    ds_read_b128 v[160:163], v7 offset:4096
    ds_read_b128 v[164:167], v7 offset:5120
    s_mov_b64 exec, 1
    ds_add_u32 v12, v13 offset:20
    s_mov_b64 exec, -1
    s_setprio 3
    s_mov_b32 s62, 131072
lp_15:
    ds_read_b32 v8, v12 offset:20
    s_waitcnt lgkmcnt(0)
    v_cmp_gt_u32 vcc, 8, v8
    s_cbranch_vccz lpd_16
    s_sleep 8
    s_sub_u32 s62, s62, 1
    s_cmp_lg_u32 s62, 0
    s_cbranch_scc1 lp_15
lpd_16:
    s_setprio 0
    ds_write_b128 v4, v[48:51] offset:0
    ds_write_b128 v4, v[52:55] offset:1024
    ds_write_b128 v4, v[56:59] offset:2048
    ds_write_b128 v4, v[60:63] offset:3072
    ds_write_b128 v4, v[72:75] offset:4096
    ds_write_b128 v4, v[76:79] offset:5120
    s_setprio 3
    s_mov_b64 exec, 1
    ds_add_u32 v12, v13 offset:20
    s_mov_b64 exec, -1
    s_waitcnt lgkmcnt(0)
    s_mov_b32 s62, 131072
lp_17:
    ds_read_b32 v8, v12 offset:20
    s_waitcnt lgkmcnt(0)
    v_cmp_gt_u32 vcc, 12, v8
    s_cbranch_vccz lpd_18
    s_sleep 8
    s_sub_u32 s62, s62, 1
    s_cmp_lg_u32 s62, 0
    s_cbranch_scc1 lp_17
lpd_18:
    s_setprio 0
    v_pk_add_f32 v[16:17], v[16:17], v[144:145]
    v_pk_add_f32 v[18:19], v[18:19], v[146:147]
    v_pk_add_f32 v[20:21], v[20:21], v[148:149]
    v_pk_add_f32 v[22:23], v[22:23], v[150:151]
    v_pk_add_f32 v[24:25], v[24:25], v[152:153]
    v_pk_add_f32 v[26:27], v[26:27], v[154:155]
    v_pk_add_f32 v[28:29], v[28:29], v[156:157]
    v_pk_add_f32 v[30:31], v[30:31], v[158:159]
    v_pk_add_f32 v[16:17], v[16:17], v[160:161]
    v_pk_add_f32 v[18:19], v[18:19], v[162:163]
    v_pk_add_f32 v[20:21], v[20:21], v[164:165]
    v_pk_add_f32 v[22:23], v[22:23], v[166:167]
    ds_read_b128 v[144:147], v6 offset:0
    ds_read_b128 v[148:151], v6 offset:1024
    ds_read_b128 v[152:155], v6 offset:2048
    ds_read_b128 v[156:159], v6 offset:3072
    ds_read_b128 v[160:163], v7 offset:4096
    ds_read_b128 v[164:167], v7 offset:5120
    s_waitcnt lgkmcnt(5)
    v_pk_add_f32 v[16:17], v[16:17], v[144:145]
    v_pk_add_f32 v[18:19], v[18:19], v[146:147]
    s_waitcnt lgkmcnt(4)
    v_pk_add_f32 v[20:21], v[20:21], v[148:149]
    v_pk_add_f32 v[22:23], v[22:23], v[150:151]
    s_waitcnt lgkmcnt(3)
    v_pk_add_f32 v[24:25], v[24:25], v[152:153]
    v_pk_add_f32 v[26:27], v[26:27], v[154:155]
    s_waitcnt lgkmcnt(2)
    v_pk_add_f32 v[28:29], v[28:29], v[156:157]
    v_pk_add_f32 v[30:31], v[30:31], v[158:159]
    s_waitcnt lgkmcnt(1)
    v_pk_add_f32 v[24:25], v[24:25], v[160:161]
    v_pk_add_f32 v[26:27], v[26:27], v[162:163]
    s_waitcnt lgkmcnt(0)
    v_pk_add_f32 v[28:29], v[28:29], v[164:165]
    v_pk_add_f32 v[30:31], v[30:31], v[166:167]
    v_pk_mul_f32 v[16:17], v[16:17], v[10:11] op_sel:[0,0] op_sel_hi:[1,0]
    v_pk_mul_f32 v[18:19], v[18:19], v[10:11] op_sel:[0,0] op_sel_hi:[1,0]
    v_pk_mul_f32 v[20:21], v[20:21], v[10:11] op_sel:[0,1] op_sel_hi:[1,1]
    v_pk_mul_f32 v[22:23], v[22:23], v[10:11] op_sel:[0,1] op_sel_hi:[1,1]
    v_pk_mul_f32 v[24:25], v[24:25], v[14:15] op_sel:[0,0] op_sel_hi:[1,0]
    v_pk_mul_f32 v[26:27], v[26:27], v[14:15] op_sel:[0,0] op_sel_hi:[1,0]
    v_pk_mul_f32 v[28:29], v[28:29], v[14:15] op_sel:[0,1] op_sel_hi:[1,1]
    v_pk_mul_f32 v[30:31], v[30:31], v[14:15] op_sel:[0,1] op_sel_hi:[1,1]
    s_lshl_b32 s13, s60, 15
    s_lshl_b32 s12, s59, 6
    s_add_u32 s13, s13, s12
    s_lshr_b32 s9, s9, 3
    s_add_u32 s16, s13, s9
    s_add_u32 s17, s16, 16384
    s_add_u32 s18, s16, 32768
    s_add_u32 s19, s16, 49152
    s_waitcnt vmcnt(0)
    s_setprio 3
    s_mov_b32 s12, 0xffff
    s_mov_b32 s62, 131072
    s_branch g_or
g_ow:
    s_sleep 2
g_or:
    ds_read_b32 v13, v3 offset:96
    s_sub_u32 s62, s62, 1
    s_cselect_b32 s9, -1, 0
    s_waitcnt lgkmcnt(0)
    v_cmp_ne_u32 vcc, 0, v13
    s_or_b32 s9, s9, vcc_lo
    s_and_b32 s9, s9, s12
    s_cbranch_scc0 g_ow
    s_andn2_b32 s12, s12, s9
    s_and_b32 s14, s9, 0xff
    s_cbranch_scc0 g_oh0
    s_bcnt1_i32_b32 s15, s14
    s_cmp_ge_u32 s15, 4
    s_cbranch_scc1 g_ob0
    s_and_b32 s14, s9, 0xf
    s_cbranch_scc0 g_on00
    s_bitcmp0_b32 s9, 0
    s_cbranch_scc1 g_os0
    ds_read_b128 v[32:35], v0 offset:0
    ds_read_b128 v[36:39], v0 offset:1024
    ds_read_b128 v[40:43], v0 offset:512
    ds_read_b128 v[44:47], v0 offset:1536
    s_waitcnt lgkmcnt(3)
    v_mfma_f32_16x16x32_bf16 v[16:19], v[80:83], v[32:35], v[16:19]
    s_waitcnt lgkmcnt(2)
    v_mfma_f32_16x16x32_bf16 v[20:23], v[80:83], v[36:39], v[20:23]
    s_waitcnt lgkmcnt(1)
    v_mfma_f32_16x16x32_bf16 v[16:19], v[84:87], v[40:43], v[16:19]
    s_waitcnt lgkmcnt(0)
    v_mfma_f32_16x16x32_bf16 v[20:23], v[84:87], v[44:47], v[20:23]
g_os0:
    s_bitcmp0_b32 s9, 1
    s_cbranch_scc1 g_os1
    ds_read_b128 v[48:51], v0 offset:4096
    ds_read_b128 v[52:55], v0 offset:5120
    ds_read_b128 v[56:59], v0 offset:4608
    ds_read_b128 v[60:63], v0 offset:5632
    s_waitcnt lgkmcnt(3)
    v_mfma_f32_16x16x32_bf16 v[16:19], v[88:91], v[48:51], v[16:19]
    s_waitcnt lgkmcnt(2)
    v_mfma_f32_16x16x32_bf16 v[20:23], v[88:91], v[52:55], v[20:23]
    s_waitcnt lgkmcnt(1)
    v_mfma_f32_16x16x32_bf16 v[16:19], v[92:95], v[56:59], v[16:19]
    s_waitcnt lgkmcnt(0)
    v_mfma_f32_16x16x32_bf16 v[20:23], v[92:95], v[60:63], v[20:23]
g_os1:
    s_bitcmp0_b32 s9, 2
    s_cbranch_scc1 g_os2
    ds_read_b128 v[32:35], v0 offset:8192
    ds_read_b128 v[36:39], v0 offset:9216
    ds_read_b128 v[40:43], v0 offset:8704
    ds_read_b128 v[44:47], v0 offset:9728
    s_waitcnt lgkmcnt(3)
    v_mfma_f32_16x16x32_bf16 v[16:19], v[96:99], v[32:35], v[16:19]
    s_waitcnt lgkmcnt(2)
    v_mfma_f32_16x16x32_bf16 v[20:23], v[96:99], v[36:39], v[20:23]
    s_waitcnt lgkmcnt(1)
    v_mfma_f32_16x16x32_bf16 v[16:19], v[100:103], v[40:43], v[16:19]
    s_waitcnt lgkmcnt(0)
    v_mfma_f32_16x16x32_bf16 v[20:23], v[100:103], v[44:47], v[20:23]
g_os2:
    s_bitcmp0_b32 s9, 3
    s_cbranch_scc1 g_os3
    ds_read_b128 v[48:51], v0 offset:12288
    ds_read_b128 v[52:55], v0 offset:13312
    ds_read_b128 v[56:59], v0 offset:12800
    ds_read_b128 v[60:63], v0 offset:13824
    s_waitcnt lgkmcnt(3)
    v_mfma_f32_16x16x32_bf16 v[16:19], v[104:107], v[48:51], v[16:19]
    s_waitcnt lgkmcnt(2)
    v_mfma_f32_16x16x32_bf16 v[20:23], v[104:107], v[52:55], v[20:23]
    s_waitcnt lgkmcnt(1)
    v_mfma_f32_16x16x32_bf16 v[16:19], v[108:111], v[56:59], v[16:19]
    s_waitcnt lgkmcnt(0)
    v_mfma_f32_16x16x32_bf16 v[20:23], v[108:111], v[60:63], v[20:23]
g_os3:
g_on00:
    s_and_b32 s14, s9, 0xf0
    s_cbranch_scc0 g_on01
    s_bitcmp0_b32 s9, 4
    s_cbranch_scc1 g_os4
    ds_read_b128 v[32:35], v0 offset:16384
    ds_read_b128 v[36:39], v0 offset:17408
    ds_read_b128 v[40:43], v0 offset:16896
    ds_read_b128 v[44:47], v0 offset:17920
    s_waitcnt lgkmcnt(3)
    v_mfma_f32_16x16x32_bf16 v[16:19], v[112:115], v[32:35], v[16:19]
    s_waitcnt lgkmcnt(2)
    v_mfma_f32_16x16x32_bf16 v[20:23], v[112:115], v[36:39], v[20:23]
    s_waitcnt lgkmcnt(1)
    v_mfma_f32_16x16x32_bf16 v[16:19], v[116:119], v[40:43], v[16:19]
    s_waitcnt lgkmcnt(0)
    v_mfma_f32_16x16x32_bf16 v[20:23], v[116:119], v[44:47], v[20:23]
g_os4:
    s_bitcmp0_b32 s9, 5
    s_cbranch_scc1 g_os5
    ds_read_b128 v[48:51], v0 offset:20480
    ds_read_b128 v[52:55], v0 offset:21504
    ds_read_b128 v[56:59], v0 offset:20992
    ds_read_b128 v[60:63], v0 offset:22016
    s_waitcnt lgkmcnt(3)
    v_mfma_f32_16x16x32_bf16 v[16:19], v[120:123], v[48:51], v[16:19]
    s_waitcnt lgkmcnt(2)
    v_mfma_f32_16x16x32_bf16 v[20:23], v[120:123], v[52:55], v[20:23]
    s_waitcnt lgkmcnt(1)
    v_mfma_f32_16x16x32_bf16 v[16:19], v[124:127], v[56:59], v[16:19]
    s_waitcnt lgkmcnt(0)
    v_mfma_f32_16x16x32_bf16 v[20:23], v[124:127], v[60:63], v[20:23]
g_os5:
    s_bitcmp0_b32 s9, 6
    s_cbranch_scc1 g_os6
    ds_read_b128 v[32:35], v0 offset:24576
    ds_read_b128 v[36:39], v0 offset:25600
    ds_read_b128 v[40:43], v0 offset:25088
    ds_read_b128 v[44:47], v0 offset:26112
    s_waitcnt lgkmcnt(3)
    v_mfma_f32_16x16x32_bf16 v[16:19], v[128:131], v[32:35], v[16:19]
    s_waitcnt lgkmcnt(2)
    v_mfma_f32_16x16x32_bf16 v[20:23], v[128:131], v[36:39], v[20:23]
    s_waitcnt lgkmcnt(1)
    v_mfma_f32_16x16x32_bf16 v[16:19], v[132:135], v[40:43], v[16:19]
    s_waitcnt lgkmcnt(0)
    v_mfma_f32_16x16x32_bf16 v[20:23], v[132:135], v[44:47], v[20:23]
g_os6:
    s_bitcmp0_b32 s9, 7
    s_cbranch_scc1 g_os7
    ds_read_b128 v[48:51], v0 offset:28672
    ds_read_b128 v[52:55], v0 offset:29696
    ds_read_b128 v[56:59], v0 offset:29184
    ds_read_b128 v[60:63], v0 offset:30208
    s_waitcnt lgkmcnt(3)
    v_mfma_f32_16x16x32_bf16 v[16:19], v[136:139], v[48:51], v[16:19]
    s_waitcnt lgkmcnt(2)
    v_mfma_f32_16x16x32_bf16 v[20:23], v[136:139], v[52:55], v[20:23]
    s_waitcnt lgkmcnt(1)
    v_mfma_f32_16x16x32_bf16 v[16:19], v[140:143], v[56:59], v[16:19]
    s_waitcnt lgkmcnt(0)
    v_mfma_f32_16x16x32_bf16 v[20:23], v[140:143], v[60:63], v[20:23]
g_os7:
g_on01:
g_oe0:
    s_and_b32 s14, s12, 0xff
    s_cbranch_scc1 g_oh0
    s_nop 4
    v_cvt_pk_bf16_f32 v144, v16, v17
    v_cvt_pk_bf16_f32 v145, v18, v19
    buffer_store_dwordx2 v[144:145], v1, s[52:55], s16 offen
    v_cvt_pk_bf16_f32 v146, v20, v21
    v_cvt_pk_bf16_f32 v147, v22, v23
    buffer_store_dwordx2 v[146:147], v1, s[52:55], s17 offen
g_oh0:
    s_and_b32 s14, s9, 0xff00
    s_cbranch_scc0 g_oh1
    s_bcnt1_i32_b32 s15, s14
    s_cmp_ge_u32 s15, 4
    s_cbranch_scc1 g_ob1
    s_and_b32 s14, s9, 0xf00
    s_cbranch_scc0 g_on10
    s_bitcmp0_b32 s9, 8
    s_cbranch_scc1 g_os8
    ds_read_b128 v[32:35], v0 offset:32768
    ds_read_b128 v[36:39], v0 offset:33792
    ds_read_b128 v[40:43], v0 offset:33280
    ds_read_b128 v[44:47], v0 offset:34304
    s_waitcnt lgkmcnt(3)
    v_mfma_f32_16x16x32_bf16 v[24:27], v[80:83], v[32:35], v[24:27]
    s_waitcnt lgkmcnt(2)
    v_mfma_f32_16x16x32_bf16 v[28:31], v[80:83], v[36:39], v[28:31]
    s_waitcnt lgkmcnt(1)
    v_mfma_f32_16x16x32_bf16 v[24:27], v[84:87], v[40:43], v[24:27]
    s_waitcnt lgkmcnt(0)
    v_mfma_f32_16x16x32_bf16 v[28:31], v[84:87], v[44:47], v[28:31]
g_os8:
    s_bitcmp0_b32 s9, 9
    s_cbranch_scc1 g_os9
    ds_read_b128 v[48:51], v0 offset:36864
    ds_read_b128 v[52:55], v0 offset:37888
    ds_read_b128 v[56:59], v0 offset:37376
    ds_read_b128 v[60:63], v0 offset:38400
    s_waitcnt lgkmcnt(3)
    v_mfma_f32_16x16x32_bf16 v[24:27], v[88:91], v[48:51], v[24:27]
    s_waitcnt lgkmcnt(2)
    v_mfma_f32_16x16x32_bf16 v[28:31], v[88:91], v[52:55], v[28:31]
    s_waitcnt lgkmcnt(1)
    v_mfma_f32_16x16x32_bf16 v[24:27], v[92:95], v[56:59], v[24:27]
    s_waitcnt lgkmcnt(0)
    v_mfma_f32_16x16x32_bf16 v[28:31], v[92:95], v[60:63], v[28:31]
g_os9:
    s_bitcmp0_b32 s9, 10
    s_cbranch_scc1 g_os10
    ds_read_b128 v[32:35], v0 offset:40960
    ds_read_b128 v[36:39], v0 offset:41984
    ds_read_b128 v[40:43], v0 offset:41472
    ds_read_b128 v[44:47], v0 offset:42496
    s_waitcnt lgkmcnt(3)
    v_mfma_f32_16x16x32_bf16 v[24:27], v[96:99], v[32:35], v[24:27]
    s_waitcnt lgkmcnt(2)
    v_mfma_f32_16x16x32_bf16 v[28:31], v[96:99], v[36:39], v[28:31]
    s_waitcnt lgkmcnt(1)
    v_mfma_f32_16x16x32_bf16 v[24:27], v[100:103], v[40:43], v[24:27]
    s_waitcnt lgkmcnt(0)
    v_mfma_f32_16x16x32_bf16 v[28:31], v[100:103], v[44:47], v[28:31]
g_os10:
    s_bitcmp0_b32 s9, 11
    s_cbranch_scc1 g_os11
    ds_read_b128 v[48:51], v0 offset:45056
    ds_read_b128 v[52:55], v0 offset:46080
    ds_read_b128 v[56:59], v0 offset:45568
    ds_read_b128 v[60:63], v0 offset:46592
    s_waitcnt lgkmcnt(3)
    v_mfma_f32_16x16x32_bf16 v[24:27], v[104:107], v[48:51], v[24:27]
    s_waitcnt lgkmcnt(2)
    v_mfma_f32_16x16x32_bf16 v[28:31], v[104:107], v[52:55], v[28:31]
    s_waitcnt lgkmcnt(1)
    v_mfma_f32_16x16x32_bf16 v[24:27], v[108:111], v[56:59], v[24:27]
    s_waitcnt lgkmcnt(0)
    v_mfma_f32_16x16x32_bf16 v[28:31], v[108:111], v[60:63], v[28:31]
g_os11:
g_on10:
    s_and_b32 s14, s9, 0xf000
    s_cbranch_scc0 g_on11
    s_bitcmp0_b32 s9, 12
    s_cbranch_scc1 g_os12
    ds_read_b128 v[32:35], v0 offset:49152
    ds_read_b128 v[36:39], v0 offset:50176
    ds_read_b128 v[40:43], v0 offset:49664
    ds_read_b128 v[44:47], v0 offset:50688
    s_waitcnt lgkmcnt(3)
    v_mfma_f32_16x16x32_bf16 v[24:27], v[112:115], v[32:35], v[24:27]
    s_waitcnt lgkmcnt(2)
    v_mfma_f32_16x16x32_bf16 v[28:31], v[112:115], v[36:39], v[28:31]
    s_waitcnt lgkmcnt(1)
    v_mfma_f32_16x16x32_bf16 v[24:27], v[116:119], v[40:43], v[24:27]
    s_waitcnt lgkmcnt(0)
    v_mfma_f32_16x16x32_bf16 v[28:31], v[116:119], v[44:47], v[28:31]
g_os12:
    s_bitcmp0_b32 s9, 13
    s_cbranch_scc1 g_os13
    ds_read_b128 v[48:51], v0 offset:53248
    ds_read_b128 v[52:55], v0 offset:54272
    ds_read_b128 v[56:59], v0 offset:53760
    ds_read_b128 v[60:63], v0 offset:54784
    s_waitcnt lgkmcnt(3)
    v_mfma_f32_16x16x32_bf16 v[24:27], v[120:123], v[48:51], v[24:27]
    s_waitcnt lgkmcnt(2)
    v_mfma_f32_16x16x32_bf16 v[28:31], v[120:123], v[52:55], v[28:31]
    s_waitcnt lgkmcnt(1)
    v_mfma_f32_16x16x32_bf16 v[24:27], v[124:127], v[56:59], v[24:27]
    s_waitcnt lgkmcnt(0)
    v_mfma_f32_16x16x32_bf16 v[28:31], v[124:127], v[60:63], v[28:31]
g_os13:
    s_bitcmp0_b32 s9, 14
    s_cbranch_scc1 g_os14
    ds_read_b128 v[32:35], v0 offset:57344
    ds_read_b128 v[36:39], v0 offset:58368
    ds_read_b128 v[40:43], v0 offset:57856
    ds_read_b128 v[44:47], v0 offset:58880
    s_waitcnt lgkmcnt(3)
    v_mfma_f32_16x16x32_bf16 v[24:27], v[128:131], v[32:35], v[24:27]
    s_waitcnt lgkmcnt(2)
    v_mfma_f32_16x16x32_bf16 v[28:31], v[128:131], v[36:39], v[28:31]
    s_waitcnt lgkmcnt(1)
    v_mfma_f32_16x16x32_bf16 v[24:27], v[132:135], v[40:43], v[24:27]
    s_waitcnt lgkmcnt(0)
    v_mfma_f32_16x16x32_bf16 v[28:31], v[132:135], v[44:47], v[28:31]
g_os14:
    s_bitcmp0_b32 s9, 15
    s_cbranch_scc1 g_os15
    ds_read_b128 v[48:51], v0 offset:61440
    ds_read_b128 v[52:55], v0 offset:62464
    ds_read_b128 v[56:59], v0 offset:61952
    ds_read_b128 v[60:63], v0 offset:62976
    s_waitcnt lgkmcnt(3)
    v_mfma_f32_16x16x32_bf16 v[24:27], v[136:139], v[48:51], v[24:27]
    s_waitcnt lgkmcnt(2)
    v_mfma_f32_16x16x32_bf16 v[28:31], v[136:139], v[52:55], v[28:31]
    s_waitcnt lgkmcnt(1)
    v_mfma_f32_16x16x32_bf16 v[24:27], v[140:143], v[56:59], v[24:27]
    s_waitcnt lgkmcnt(0)
    v_mfma_f32_16x16x32_bf16 v[28:31], v[140:143], v[60:63], v[28:31]
g_os15:
g_on11:
g_oe1:
    s_and_b32 s14, s12, 0xff00
    s_cbranch_scc1 g_oh1
    s_nop 4
    v_cvt_pk_bf16_f32 v148, v24, v25
    v_cvt_pk_bf16_f32 v149, v26, v27
    buffer_store_dwordx2 v[148:149], v1, s[52:55], s18 offen
    v_cvt_pk_bf16_f32 v150, v28, v29
    v_cvt_pk_bf16_f32 v151, v30, v31
    buffer_store_dwordx2 v[150:151], v1, s[52:55], s19 offen
g_oh1:
    s_cmp_lg_u32 s12, 0
    s_cbranch_scc1 g_or
    s_branch k_fin
g_ob0:
    ds_read_b128 v[32:35], v0 offset:0
    ds_read_b128 v[36:39], v0 offset:1024
    ds_read_b128 v[40:43], v0 offset:512
    ds_read_b128 v[44:47], v0 offset:1536
    ds_read_b128 v[48:51], v0 offset:4096
    ds_read_b128 v[52:55], v0 offset:5120
    ds_read_b128 v[56:59], v0 offset:4608
    ds_read_b128 v[60:63], v0 offset:5632
    ds_read_b128 v[64:67], v0 offset:8192
    ds_read_b128 v[68:71], v0 offset:9216
    ds_read_b128 v[72:75], v0 offset:8704
    ds_read_b128 v[76:79], v0 offset:9728
    s_bitcmp0_b32 s9, 0
    s_waitcnt lgkmcnt(8)
    s_cbranch_scc1 g_ot0
    v_mfma_f32_16x16x32_bf16 v[16:19], v[80:83], v[32:35], v[16:19]
    v_mfma_f32_16x16x32_bf16 v[20:23], v[80:83], v[36:39], v[20:23]
    v_mfma_f32_16x16x32_bf16 v[16:19], v[84:87], v[40:43], v[16:19]
    v_mfma_f32_16x16x32_bf16 v[20:23], v[84:87], v[44:47], v[20:23]
g_ot0:
    ds_read_b128 v[32:35], v0 offset:12288
    ds_read_b128 v[36:39], v0 offset:13312
    ds_read_b128 v[40:43], v0 offset:12800
    ds_read_b128 v[44:47], v0 offset:13824
    s_bitcmp0_b32 s9, 1
    s_waitcnt lgkmcnt(8)
    s_cbranch_scc1 g_ot1
    v_mfma_f32_16x16x32_bf16 v[16:19], v[88:91], v[48:51], v[16:19]
    v_mfma_f32_16x16x32_bf16 v[20:23], v[88:91], v[52:55], v[20:23]
    v_mfma_f32_16x16x32_bf16 v[16:19], v[92:95], v[56:59], v[16:19]
    v_mfma_f32_16x16x32_bf16 v[20:23], v[92:95], v[60:63], v[20:23]
g_ot1:
    ds_read_b128 v[48:51], v0 offset:16384
    ds_read_b128 v[52:55], v0 offset:17408
    ds_read_b128 v[56:59], v0 offset:16896
    ds_read_b128 v[60:63], v0 offset:17920
    s_bitcmp0_b32 s9, 2
    s_waitcnt lgkmcnt(8)
    s_cbranch_scc1 g_ot2
    v_mfma_f32_16x16x32_bf16 v[16:19], v[96:99], v[64:67], v[16:19]
    v_mfma_f32_16x16x32_bf16 v[20:23], v[96:99], v[68:71], v[20:23]
    v_mfma_f32_16x16x32_bf16 v[16:19], v[100:103], v[72:75], v[16:19]
    v_mfma_f32_16x16x32_bf16 v[20:23], v[100:103], v[76:79], v[20:23]
g_ot2:
    ds_read_b128 v[64:67], v0 offset:20480
    ds_read_b128 v[68:71], v0 offset:21504
    ds_read_b128 v[72:75], v0 offset:20992
    ds_read_b128 v[76:79], v0 offset:22016
    s_bitcmp0_b32 s9, 3
    s_waitcnt lgkmcnt(8)
    s_cbranch_scc1 g_ot3
    v_mfma_f32_16x16x32_bf16 v[16:19], v[104:107], v[32:35], v[16:19]
    v_mfma_f32_16x16x32_bf16 v[20:23], v[104:107], v[36:39], v[20:23]
    v_mfma_f32_16x16x32_bf16 v[16:19], v[108:111], v[40:43], v[16:19]
    v_mfma_f32_16x16x32_bf16 v[20:23], v[108:111], v[44:47], v[20:23]
g_ot3:
    ds_read_b128 v[32:35], v0 offset:24576
    ds_read_b128 v[36:39], v0 offset:25600
    ds_read_b128 v[40:43], v0 offset:25088
    ds_read_b128 v[44:47], v0 offset:26112
    s_bitcmp0_b32 s9, 4
    s_waitcnt lgkmcnt(8)
    s_cbranch_scc1 g_ot4
    v_mfma_f32_16x16x32_bf16 v[16:19], v[112:115], v[48:51], v[16:19]
    v_mfma_f32_16x16x32_bf16 v[20:23], v[112:115], v[52:55], v[20:23]
    v_mfma_f32_16x16x32_bf16 v[16:19], v[116:119], v[56:59], v[16:19]
    v_mfma_f32_16x16x32_bf16 v[20:23], v[116:119], v[60:63], v[20:23]
g_ot4:
    ds_read_b128 v[48:51], v0 offset:28672
    ds_read_b128 v[52:55], v0 offset:29696
    ds_read_b128 v[56:59], v0 offset:29184
    ds_read_b128 v[60:63], v0 offset:30208
    s_bitcmp0_b32 s9, 5
    s_waitcnt lgkmcnt(8)
    s_cbranch_scc1 g_ot5
    v_mfma_f32_16x16x32_bf16 v[16:19], v[120:123], v[64:67], v[16:19]
    v_mfma_f32_16x16x32_bf16 v[20:23], v[120:123], v[68:71], v[20:23]
    v_mfma_f32_16x16x32_bf16 v[16:19], v[124:127], v[72:75], v[16:19]
    v_mfma_f32_16x16x32_bf16 v[20:23], v[124:127], v[76:79], v[20:23]
g_ot5:
    s_bitcmp0_b32 s9, 6
    s_waitcnt lgkmcnt(4)
    s_cbranch_scc1 g_ot6
    v_mfma_f32_16x16x32_bf16 v[16:19], v[128:131], v[32:35], v[16:19]
    v_mfma_f32_16x16x32_bf16 v[20:23], v[128:131], v[36:39], v[20:23]
    v_mfma_f32_16x16x32_bf16 v[16:19], v[132:135], v[40:43], v[16:19]
    v_mfma_f32_16x16x32_bf16 v[20:23], v[132:135], v[44:47], v[20:23]
g_ot6:
    s_bitcmp0_b32 s9, 7
    s_waitcnt lgkmcnt(0)
    s_cbranch_scc1 g_ot7
    v_mfma_f32_16x16x32_bf16 v[16:19], v[136:139], v[48:51], v[16:19]
    v_mfma_f32_16x16x32_bf16 v[20:23], v[136:139], v[52:55], v[20:23]
    v_mfma_f32_16x16x32_bf16 v[16:19], v[140:143], v[56:59], v[16:19]
    v_mfma_f32_16x16x32_bf16 v[20:23], v[140:143], v[60:63], v[20:23]
g_ot7:
    s_branch g_oe0
g_ob1:
    ds_read_b128 v[32:35], v0 offset:32768
    ds_read_b128 v[36:39], v0 offset:33792
    ds_read_b128 v[40:43], v0 offset:33280
    ds_read_b128 v[44:47], v0 offset:34304
    ds_read_b128 v[48:51], v0 offset:36864
    ds_read_b128 v[52:55], v0 offset:37888
    ds_read_b128 v[56:59], v0 offset:37376
    ds_read_b128 v[60:63], v0 offset:38400
    ds_read_b128 v[64:67], v0 offset:40960
    ds_read_b128 v[68:71], v0 offset:41984
    ds_read_b128 v[72:75], v0 offset:41472
    ds_read_b128 v[76:79], v0 offset:42496
    s_bitcmp0_b32 s9, 8
    s_waitcnt lgkmcnt(8)
    s_cbranch_scc1 g_ot8
    v_mfma_f32_16x16x32_bf16 v[24:27], v[80:83], v[32:35], v[24:27]
    v_mfma_f32_16x16x32_bf16 v[28:31], v[80:83], v[36:39], v[28:31]
    v_mfma_f32_16x16x32_bf16 v[24:27], v[84:87], v[40:43], v[24:27]
    v_mfma_f32_16x16x32_bf16 v[28:31], v[84:87], v[44:47], v[28:31]
g_ot8:
    ds_read_b128 v[32:35], v0 offset:45056
    ds_read_b128 v[36:39], v0 offset:46080
    ds_read_b128 v[40:43], v0 offset:45568
    ds_read_b128 v[44:47], v0 offset:46592
    s_bitcmp0_b32 s9, 9
    s_waitcnt lgkmcnt(8)
    s_cbranch_scc1 g_ot9
    v_mfma_f32_16x16x32_bf16 v[24:27], v[88:91], v[48:51], v[24:27]
    v_mfma_f32_16x16x32_bf16 v[28:31], v[88:91], v[52:55], v[28:31]
    v_mfma_f32_16x16x32_bf16 v[24:27], v[92:95], v[56:59], v[24:27]
    v_mfma_f32_16x16x32_bf16 v[28:31], v[92:95], v[60:63], v[28:31]
g_ot9:
    ds_read_b128 v[48:51], v0 offset:49152
    ds_read_b128 v[52:55], v0 offset:50176
    ds_read_b128 v[56:59], v0 offset:49664
    ds_read_b128 v[60:63], v0 offset:50688
    s_bitcmp0_b32 s9, 10
    s_waitcnt lgkmcnt(8)
    s_cbranch_scc1 g_ot10
    v_mfma_f32_16x16x32_bf16 v[24:27], v[96:99], v[64:67], v[24:27]
    v_mfma_f32_16x16x32_bf16 v[28:31], v[96:99], v[68:71], v[28:31]
    v_mfma_f32_16x16x32_bf16 v[24:27], v[100:103], v[72:75], v[24:27]
    v_mfma_f32_16x16x32_bf16 v[28:31], v[100:103], v[76:79], v[28:31]
g_ot10:
    ds_read_b128 v[64:67], v0 offset:53248
    ds_read_b128 v[68:71], v0 offset:54272
    ds_read_b128 v[72:75], v0 offset:53760
    ds_read_b128 v[76:79], v0 offset:54784
    s_bitcmp0_b32 s9, 11
    s_waitcnt lgkmcnt(8)
    s_cbranch_scc1 g_ot11
    v_mfma_f32_16x16x32_bf16 v[24:27], v[104:107], v[32:35], v[24:27]
    v_mfma_f32_16x16x32_bf16 v[28:31], v[104:107], v[36:39], v[28:31]
    v_mfma_f32_16x16x32_bf16 v[24:27], v[108:111], v[40:43], v[24:27]
    v_mfma_f32_16x16x32_bf16 v[28:31], v[108:111], v[44:47], v[28:31]
g_ot11:
    ds_read_b128 v[32:35], v0 offset:57344
    ds_read_b128 v[36:39], v0 offset:58368
    ds_read_b128 v[40:43], v0 offset:57856
    ds_read_b128 v[44:47], v0 offset:58880
    s_bitcmp0_b32 s9, 12
    s_waitcnt lgkmcnt(8)
    s_cbranch_scc1 g_ot12
    v_mfma_f32_16x16x32_bf16 v[24:27], v[112:115], v[48:51], v[24:27]
    v_mfma_f32_16x16x32_bf16 v[28:31], v[112:115], v[52:55], v[28:31]
    v_mfma_f32_16x16x32_bf16 v[24:27], v[116:119], v[56:59], v[24:27]
    v_mfma_f32_16x16x32_bf16 v[28:31], v[116:119], v[60:63], v[28:31]
g_ot12:
    ds_read_b128 v[48:51], v0 offset:61440
    ds_read_b128 v[52:55], v0 offset:62464
    ds_read_b128 v[56:59], v0 offset:61952
    ds_read_b128 v[60:63], v0 offset:62976
    s_bitcmp0_b32 s9, 13
    s_waitcnt lgkmcnt(8)
    s_cbranch_scc1 g_ot13
    v_mfma_f32_16x16x32_bf16 v[24:27], v[120:123], v[64:67], v[24:27]
    v_mfma_f32_16x16x32_bf16 v[28:31], v[120:123], v[68:71], v[28:31]
    v_mfma_f32_16x16x32_bf16 v[24:27], v[124:127], v[72:75], v[24:27]
    v_mfma_f32_16x16x32_bf16 v[28:31], v[124:127], v[76:79], v[28:31]
g_ot13:
    s_bitcmp0_b32 s9, 14
    s_waitcnt lgkmcnt(4)
    s_cbranch_scc1 g_ot14
    v_mfma_f32_16x16x32_bf16 v[24:27], v[128:131], v[32:35], v[24:27]
    v_mfma_f32_16x16x32_bf16 v[28:31], v[128:131], v[36:39], v[28:31]
    v_mfma_f32_16x16x32_bf16 v[24:27], v[132:135], v[40:43], v[24:27]
    v_mfma_f32_16x16x32_bf16 v[28:31], v[132:135], v[44:47], v[28:31]
g_ot14:
    s_bitcmp0_b32 s9, 15
    s_waitcnt lgkmcnt(0)
    s_cbranch_scc1 g_ot15
    v_mfma_f32_16x16x32_bf16 v[24:27], v[136:139], v[48:51], v[24:27]
    v_mfma_f32_16x16x32_bf16 v[28:31], v[136:139], v[52:55], v[28:31]
    v_mfma_f32_16x16x32_bf16 v[24:27], v[140:143], v[56:59], v[24:27]
    v_mfma_f32_16x16x32_bf16 v[28:31], v[140:143], v[60:63], v[28:31]
g_ot15:
    s_branch g_oe1
a_p1:
    s_lshr_b32 s5, s3, 3
    s_lshl1_add_u32 s85, s84, s5
    v_and_b32 v4, 15, v0
    v_bfe_u32 v9, v0, 1, 3
    v_lshrrev_b32 v3, 4, v0
    v_xor_b32 v5, v9, v3
    v_lshlrev_b32 v5, 4, v5
    v_lshl_add_u32 v4, v4, 7, v5
    s_lshl_b32 s10, s84, 13
    s_add_u32 s10, s10, 49152
    v_add_u32 v4, s10, v4
    v_xor_b32 v5, 64, v4
    s_waitcnt lgkmcnt(0)
    s_mov_b32 s40, s38
    s_and_b32 s41, s39, 0xffff
    s_mov_b32 s42, 0x10000000
    s_mov_b32 s43, 0x00020000
    s_cmp_lg_u32 s85, 1
    s_cbranch_scc1 h_done
    s_lshl_b32 s6, s88, 8
    s_add_u32 s6, s6, 25231360
    s_lshl_b32 s7, s56, 8
    s_add_u32 s7, s7, 25251840
    v_cmp_eq_u32 vcc, 0, v0
    v_mov_b32 v20, s6
    v_mov_b32 v21, s7
    v_cndmask_b32 v20, v21, v20, vcc
    buffer_load_dword v1, v20, s[40:43], 0 offen sc1
    v_and_b32 v24, 15, v0
    v_cmp_eq_u32 vcc, 0, v24
    v_mov_b32 v25, 0x3f803f80
    v_add_u32 v24, 159744, v2
    v_cndmask_b32 v28, 0, v25, vcc
    v_cmp_gt_u32 vcc, 48, v0
    v_mov_b32 v29, v28
    v_mov_b32 v30, v28
    v_mov_b32 v31, v28
    v_cndmask_b32 v32, 0, v28, vcc
    v_mov_b32 v33, v32
    v_mov_b32 v34, v32
    v_mov_b32 v35, v32
    ds_write_b128 v24, v[28:31] offset:0
    ds_write_b128 v24, v[28:31] offset:1024
    ds_write_b128 v24, v[28:31] offset:2048
    ds_write_b128 v24, v[32:35] offset:3072
h_done:
    v_bfe_u32 v10, v0, 2, 2
    v_lshlrev_b32 v8, 7, v10
    v_bfe_u32 v10, v0, 3, 1
    v_lshl_add_u32 v8, v10, 6, v8
    v_bfe_u32 v13, v0, 4, 1
    v_lshl_add_u32 v8, v13, 5, v8
    v_and_b32 v10, 3, v0
    v_lshl_add_u32 v8, v10, 3, v8
    v_cmp_ne_u32 s[12:13], 0, v13
    v_mov_b32 v14, 163584
    v_mov_b32 v15, 1
    v_and_b32 v11, 15, v0
    v_lshrrev_b32 v10, 5, v0
    v_lshl_add_u32 v10, v10, 4, v11
    v_lshlrev_b32 v10, 4, v10
    s_lshr_b32 s44, s84, 1
    s_lshl_b32 s44, s44, 13
    s_add_u32 s45, s44, 4096
    v_add_u32 v10, s45, v10
    s_and_b32 s45, s84, 1
    s_lshl_b32 s45, s45, 11
    s_add_u32 s45, s45, s44
    s_lshr_b32 s46, s3, 3
    s_lshl_b32 s47, s46, 16
    s_add_u32 s45, s45, s47
    s_mul_i32 s46, s46, 20
    s_add_u32 s46, s46, 163592
    v_min_u32 v11, 1, v11
    v_lshlrev_b32 v11, 4, v11
    v_add_u32 v12, 159744, v11
    v_cndmask_b32 v12, v10, v12, s[12:13]
    s_lshr_b32 s4, s85, 2
    s_lshl_b32 s4, s4, 13
    s_and_b32 s5, s85, 3
    s_lshl_b32 s5, s5, 10
    s_add_u32 s8, s4, s5
    s_lshl_b32 s9, s84, 13
    s_add_u32 s9, s9, 65536
    v_pk_mul_f32 v[152:153], 0, 0
    v_pk_mul_f32 v[154:155], 0, 0
    v_pk_mul_f32 v[156:157], 0, 0
    v_pk_mul_f32 v[158:159], 0, 0
    v_pk_mul_f32 v[160:161], 0, 0
    v_pk_mul_f32 v[162:163], 0, 0
    v_pk_mul_f32 v[164:165], 0, 0
    v_pk_mul_f32 v[166:167], 0, 0
    s_mov_b32 s63, 4
    s_mov_b32 s14, 49152
    s_mov_b32 s15, 0x00100100
    s_mov_b32 s6, 0x3eb8aa3b
    s_mov_b32 s7, s6
    s_mov_b32 s20, 0
    s_mov_b32 s23, 0x9114
    s_lshr_b32 s28, s3, 3
    s_mov_b32 s29, 0
    s_lshl3_add_u32 s4, s87, s85
    s_mul_i32 s30, s4, 144
    s_add_u32 s30, s30, s88
    s_lshl_b32 s30, s30, 10
    s_add_u32 s30, s30, 8503296
    s_lshl_b32 s4, s84, 10
    s_add_u32 s21, s4, 151552
    s_and_b32 s5, s85, 1
    s_lshl_b32 s5, s5, 7
    s_add_u32 s4, s4, s5
    s_add_u32 s31, s4, 160000
    s_lshl2_add_u32 s22, s85, 163584
    s_cmp_ge_u32 s3, 8
    s_cbranch_scc1 y_p1
    v_lshl_add_u32 v6, v3, 10, v8
    v_add_u32 v6, 81920, v6
    v_xor_b32 v7, 32, v6
    v_xor_b32 v8, 64, v6
    v_lshrrev_b32 v10, 5, v0
    v_lshlrev_b32 v10, 8, v10
    v_lshl_add_u32 v10, v13, 3, v10
    v_and_b32 v11, 3, v0
    v_lshl_add_u32 v10, v11, 4, v10
    v_bfe_u32 v11, v0, 2, 1
    v_lshl_add_u32 v10, v11, 7, v10
    v_bfe_u32 v11, v0, 3, 1
    v_lshl_add_u32 v10, v11, 6, v10
    s_add_u32 s4, s8, 4096
    v_add_u32 v10, s4, v10
    v_add_u32 v3, s8, v2
    v_add_u32 v9, s21, v2
    v_mov_b32 v13, s22
    v_pk_mul_f32 v[16:17], 0, 0
    v_pk_mul_f32 v[18:19], 0, 0
    v_pk_mul_f32 v[20:21], 0, 0
    v_pk_mul_f32 v[22:23], 0, 0
    v_pk_mul_f32 v[24:25], 0, 0
    v_pk_mul_f32 v[26:27], 0, 0
    v_pk_mul_f32 v[28:29], 0, 0
    v_pk_mul_f32 v[30:31], 0, 0
    v_pk_mul_f32 v[32:33], 0, 0
    v_pk_mul_f32 v[34:35], 0, 0
    v_pk_mul_f32 v[36:37], 0, 0
    v_pk_mul_f32 v[38:39], 0, 0
    v_pk_mul_f32 v[40:41], 0, 0
    v_pk_mul_f32 v[42:43], 0, 0
    v_pk_mul_f32 v[44:45], 0, 0
    v_pk_mul_f32 v[46:47], 0, 0
    v_pk_mul_f32 v[48:49], 0, 0
    v_pk_mul_f32 v[50:51], 0, 0
    v_pk_mul_f32 v[52:53], 0, 0
    v_pk_mul_f32 v[54:55], 0, 0
    v_pk_mul_f32 v[56:57], 0, 0
    v_pk_mul_f32 v[58:59], 0, 0
    v_pk_mul_f32 v[60:61], 0, 0
    v_pk_mul_f32 v[62:63], 0, 0
    s_waitcnt lgkmcnt(0)
    s_barrier
    ds_read_b64_tr_b16 v[64:65], v6 offset:0
    ds_read_b64_tr_b16 v[66:67], v6 offset:512
    ds_read_b128 v[112:115], v4 offset:0
    ds_read_b128 v[116:119], v4 offset:2048
    ds_read_b128 v[120:123], v4 offset:4096
    ds_read_b128 v[124:127], v4 offset:6144
    ds_read_b64_tr_b16 v[68:69], v7 offset:0
    ds_read_b64_tr_b16 v[70:71], v7 offset:512
a_l1:
    s_bitcmp1_b32 s15, s63
    s_cselect_b32 s10, 4294868992, s14
    s_waitcnt lgkmcnt(5)
    v_mfma_f32_16x16x32_bf16 v[16:19], v[64:67], v[112:115], v[16:19]
    ds_read_b64_tr_b16 v[72:73], v8 offset:0
    s_waitcnt lgkmcnt(5)
    v_mfma_f32_16x16x32_bf16 v[20:23], v[64:67], v[116:119], v[20:23]
    ds_read_b64_tr_b16 v[74:75], v8 offset:512
    s_waitcnt lgkmcnt(5)
    v_mfma_f32_16x16x32_bf16 v[24:27], v[64:67], v[120:123], v[24:27]
    ds_read_b64_tr_b16 v[76:77], v6 offset:4096
    s_waitcnt lgkmcnt(5)
    v_mfma_f32_16x16x32_bf16 v[28:31], v[64:67], v[124:127], v[28:31]
    ds_read_b64_tr_b16 v[78:79], v6 offset:4608
    s_waitcnt lgkmcnt(4)
    v_mfma_f32_16x16x32_bf16 v[32:35], v[68:71], v[112:115], v[32:35]
    ds_read_b128 v[128:131], v5 offset:0
    v_mfma_f32_16x16x32_bf16 v[36:39], v[68:71], v[116:119], v[36:39]
    ds_read_b128 v[132:135], v5 offset:2048
    v_mfma_f32_16x16x32_bf16 v[40:43], v[68:71], v[120:123], v[40:43]
    ds_read_b128 v[136:139], v5 offset:4096
    v_mfma_f32_16x16x32_bf16 v[44:47], v[68:71], v[124:127], v[44:47]
    ds_read_b128 v[140:143], v5 offset:6144
    s_waitcnt lgkmcnt(6)
    v_mfma_f32_16x16x32_bf16 v[48:51], v[112:115], v[72:75], v[48:51]
    ds_read_b64_tr_b16 v[80:81], v7 offset:4096
    v_mfma_f32_16x16x32_bf16 v[52:55], v[116:119], v[72:75], v[52:55]
    ds_read_b64_tr_b16 v[82:83], v7 offset:4608
    v_mfma_f32_16x16x32_bf16 v[56:59], v[120:123], v[72:75], v[56:59]
    ds_read_b64_tr_b16 v[84:85], v8 offset:4096
    v_mfma_f32_16x16x32_bf16 v[60:63], v[124:127], v[72:75], v[60:63]
    ds_read_b64_tr_b16 v[86:87], v8 offset:4608
    s_waitcnt lgkmcnt(6)
    v_mfma_f32_16x16x32_bf16 v[16:19], v[76:79], v[128:131], v[16:19]
    v_mfma_f32_16x16x32_bf16 v[20:23], v[76:79], v[132:135], v[20:23]
    s_waitcnt lgkmcnt(5)
    v_mfma_f32_16x16x32_bf16 v[24:27], v[76:79], v[136:139], v[24:27]
    s_waitcnt lgkmcnt(4)
    v_mfma_f32_16x16x32_bf16 v[28:31], v[76:79], v[140:143], v[28:31]
    s_add_u32 s63, s63, 4
    s_cmp_eq_u32 s63, 32
    s_waitcnt vmcnt(0) lgkmcnt(0)
    v_add_u32 v6, s10, v6
    v_add_u32 v4, s10, v4
    v_add_u32 v7, s10, v7
    v_add_u32 v8, s10, v8
    v_add_u32 v5, s10, v5
    s_cbranch_scc1 a_last
    s_barrier
    v_mfma_f32_16x16x32_bf16 v[32:35], v[80:83], v[128:131], v[32:35]
    ds_read_b64_tr_b16 v[64:65], v6 offset:0
    v_mfma_f32_16x16x32_bf16 v[36:39], v[80:83], v[132:135], v[36:39]
    ds_read_b64_tr_b16 v[66:67], v6 offset:512
    v_mfma_f32_16x16x32_bf16 v[40:43], v[80:83], v[136:139], v[40:43]
    ds_read_b128 v[112:115], v4 offset:0
    v_mfma_f32_16x16x32_bf16 v[44:47], v[80:83], v[140:143], v[44:47]
    ds_read_b128 v[116:119], v4 offset:2048
    v_mfma_f32_16x16x32_bf16 v[48:51], v[128:131], v[84:87], v[48:51]
    ds_read_b128 v[120:123], v4 offset:4096
    v_mfma_f32_16x16x32_bf16 v[52:55], v[132:135], v[84:87], v[52:55]
    ds_read_b128 v[124:127], v4 offset:6144
    v_mfma_f32_16x16x32_bf16 v[56:59], v[136:139], v[84:87], v[56:59]
    ds_read_b64_tr_b16 v[68:69], v7 offset:0
    v_mfma_f32_16x16x32_bf16 v[60:63], v[140:143], v[84:87], v[60:63]
    ds_read_b64_tr_b16 v[70:71], v7 offset:512
    s_branch a_l1
a_last:
    v_mfma_f32_16x16x32_bf16 v[32:35], v[80:83], v[128:131], v[32:35]
    v_mfma_f32_16x16x32_bf16 v[36:39], v[80:83], v[132:135], v[36:39]
    v_mfma_f32_16x16x32_bf16 v[40:43], v[80:83], v[136:139], v[40:43]
    v_mfma_f32_16x16x32_bf16 v[44:47], v[80:83], v[140:143], v[44:47]
    v_mfma_f32_16x16x32_bf16 v[48:51], v[128:131], v[84:87], v[48:51]
    v_mfma_f32_16x16x32_bf16 v[52:55], v[132:135], v[84:87], v[52:55]
    v_mfma_f32_16x16x32_bf16 v[56:59], v[136:139], v[84:87], v[56:59]
    v_mfma_f32_16x16x32_bf16 v[60:63], v[140:143], v[84:87], v[60:63]
    s_setprio 2
    s_barrier
    ds_read_b64_tr_b16 v[68:69], v7 offset:0
    ds_read_b64_tr_b16 v[70:71], v7 offset:512
    ds_read_b128 v[112:115], v4 offset:0
    ds_read_b128 v[116:119], v4 offset:2048
    ds_read_b128 v[120:123], v4 offset:4096
    ds_read_b128 v[124:127], v4 offset:6144
    ds_read_b64_tr_b16 v[72:73], v8 offset:0
    ds_read_b64_tr_b16 v[74:75], v8 offset:512
    ds_read_b64_tr_b16 v[80:81], v7 offset:4096
    ds_read_b64_tr_b16 v[82:83], v7 offset:4608
    ds_read_b128 v[128:131], v5 offset:0
    ds_read_b128 v[132:135], v5 offset:2048
    ds_read_b128 v[136:139], v5 offset:4096
    ds_read_b128 v[140:143], v5 offset:6144
    ds_read_b64_tr_b16 v[84:85], v8 offset:4096
    ds_read_b64_tr_b16 v[86:87], v8 offset:4608
    s_waitcnt lgkmcnt(13)
    v_mfma_f32_16x16x32_bf16 v[32:35], v[68:71], v[112:115], v[32:35]
    s_waitcnt lgkmcnt(12)
    v_mfma_f32_16x16x32_bf16 v[36:39], v[68:71], v[116:119], v[36:39]
    ds_read_b64_tr_b16 v[64:65], v6 offset:0
    ds_read_b64_tr_b16 v[66:67], v6 offset:512
    s_waitcnt lgkmcnt(13)
    v_mfma_f32_16x16x32_bf16 v[40:43], v[68:71], v[120:123], v[40:43]
    s_waitcnt lgkmcnt(12)
    v_mfma_f32_16x16x32_bf16 v[44:47], v[68:71], v[124:127], v[44:47]
    ds_read_b64_tr_b16 v[76:77], v6 offset:4096
    ds_read_b64_tr_b16 v[78:79], v6 offset:4608
    s_waitcnt lgkmcnt(12)
    v_mfma_f32_16x16x32_bf16 v[48:51], v[112:115], v[72:75], v[48:51]
    v_mfma_f32_16x16x32_bf16 v[52:55], v[116:119], v[72:75], v[52:55]
    v_mfma_f32_16x16x32_bf16 v[56:59], v[120:123], v[72:75], v[56:59]
    v_mfma_f32_16x16x32_bf16 v[60:63], v[124:127], v[72:75], v[60:63]
    s_waitcnt lgkmcnt(9)
    v_mfma_f32_16x16x32_bf16 v[32:35], v[80:83], v[128:131], v[32:35]
    s_waitcnt lgkmcnt(8)
    v_mfma_f32_16x16x32_bf16 v[36:39], v[80:83], v[132:135], v[36:39]
    s_waitcnt lgkmcnt(7)
    v_mfma_f32_16x16x32_bf16 v[40:43], v[80:83], v[136:139], v[40:43]
    s_waitcnt lgkmcnt(6)
    v_mfma_f32_16x16x32_bf16 v[44:47], v[80:83], v[140:143], v[44:47]
    s_waitcnt lgkmcnt(4)
    v_mfma_f32_16x16x32_bf16 v[48:51], v[128:131], v[84:87], v[48:51]
    v_mfma_f32_16x16x32_bf16 v[52:55], v[132:135], v[84:87], v[52:55]
    v_mfma_f32_16x16x32_bf16 v[56:59], v[136:139], v[84:87], v[56:59]
    v_mfma_f32_16x16x32_bf16 v[60:63], v[140:143], v[84:87], v[60:63]
    s_waitcnt lgkmcnt(0)
    v_mfma_f32_16x16x32_bf16 v[16:19], v[64:67], v[112:115], v[16:19]
    v_cvt_pk_bf16_f32 v92, v32, v33
    v_cvt_pk_bf16_f32 v93, v34, v35
    v_cvt_pk_bf16_f32 v94, v36, v37
    v_cvt_pk_bf16_f32 v95, v38, v39
    v_mfma_f32_16x16x32_bf16 v[20:23], v[64:67], v[116:119], v[20:23]
    v_cvt_pk_bf16_f32 v100, v40, v41
    v_cvt_pk_bf16_f32 v101, v42, v43
    v_cvt_pk_bf16_f32 v102, v44, v45
    v_cvt_pk_bf16_f32 v103, v46, v47
    v_mfma_f32_16x16x32_bf16 v[16:19], v[76:79], v[128:131], v[16:19]
    v_permlane16_swap_b32 v92, v94
    v_permlane16_swap_b32 v93, v95
    v_cvt_pk_bf16_f32 v96, v48, v49
    v_cvt_pk_bf16_f32 v97, v50, v51
    v_cvt_pk_bf16_f32 v98, v52, v53
    v_cvt_pk_bf16_f32 v99, v54, v55
    v_mfma_f32_16x16x32_bf16 v[20:23], v[76:79], v[132:135], v[20:23]
    v_permlane16_swap_b32 v100, v102
    v_permlane16_swap_b32 v101, v103
    ds_write_b128 v3, v[92:95]
    v_cvt_pk_bf16_f32 v104, v56, v57
    v_cvt_pk_bf16_f32 v105, v58, v59
    v_cvt_pk_bf16_f32 v106, v60, v61
    v_cvt_pk_bf16_f32 v107, v62, v63
    ds_write2_b64 v10, v[96:97], v[98:99] offset1:64
    ds_write_b128 v3, v[100:103] offset:1024
    ds_write2_b64 v10, v[104:105], v[106:107] offset0:128 offset1:192
    ds_write2_b32 v13, v15, v15 offset0:8 offset1:9
    v_mfma_f32_16x16x32_bf16 v[24:27], v[64:67], v[120:123], v[24:27]
    v_mfma_f32_16x16x32_bf16 v[28:31], v[64:67], v[124:127], v[28:31]
    v_pk_mul_f32 v[16:17], v[16:17], s[6:7]
    v_pk_mul_f32 v[18:19], v[18:19], s[6:7]
    v_pk_mul_f32 v[20:21], v[20:21], s[6:7]
    v_pk_mul_f32 v[22:23], v[22:23], s[6:7]
    v_mfma_f32_16x16x32_bf16 v[24:27], v[76:79], v[136:139], v[24:27]
    v_cvt_pk_bf16_f32 v88, v16, v17
    v_cvt_pk_bf16_f32 v89, v18, v19
    v_cvt_pk_bf16_f32 v90, v20, v21
    v_cvt_pk_bf16_f32 v91, v22, v23
    v_mfma_f32_16x16x32_bf16 v[28:31], v[76:79], v[140:143], v[28:31]
    s_nop 0
    v_permlane16_swap_b32 v88, v90
    v_permlane16_swap_b32 v89, v91
    ds_write_b128 v9, v[88:91] offset:4096
    ds_write_b32 v13, v15 offset:180
    v_mfma_f32_32x32x16_bf16 v[32:47], v[92:95], v[88:91], 0
    v_mov_b32 v5, 0x4000
    v_cndmask_b32 v5, v5, 0, s[12:13]
    v_and_b32 v8, 7, v0
    v_lshl_add_u32 v8, v8, 2, v14
    v_xor_b32 v130, 16, v13
    v_add_u32 v6, 148, v130
    v_cndmask_b32 v8, v8, v6, s[12:13]
    v_xor_b32 v7, 0x800, v9
    v_pk_mul_f32 v[24:25], v[24:25], s[6:7]
    v_pk_mul_f32 v[26:27], v[26:27], s[6:7]
    v_pk_mul_f32 v[28:29], v[28:29], s[6:7]
    v_pk_mul_f32 v[30:31], v[30:31], s[6:7]
    v_cvt_pk_bf16_f32 v144, v24, v25
    v_cvt_pk_bf16_f32 v145, v26, v27
    v_cvt_pk_bf16_f32 v146, v28, v29
    v_cvt_pk_bf16_f32 v147, v30, v31
    s_nop 1
    v_permlane16_swap_b32 v144, v146
    v_permlane16_swap_b32 v145, v147
    ds_write_b128 v9, v[144:147]
    ds_write_b32 v13, v15 offset:176
    s_nop 2
    v_max3_f32 v108, v32, v33, v34
    v_max3_f32 v108, v108, v35, v36
    v_max3_f32 v108, v108, v37, v38
    v_max3_f32 v108, v108, v39, v40
    v_max3_f32 v108, v108, v41, v42
    v_max3_f32 v108, v108, v43, v44
    v_max3_f32 v108, v108, v45, v46
    v_max_f32 v108, v108, v47
a_hd:
    v_add_u32 v3, s44, v2
    s_mov_b32 s62, 131072
lp_19:
    ds_read_b32 v6, v8 offset:32
    s_waitcnt lgkmcnt(0)
    v_cmp_gt_u32 vcc, 1, v6
    s_cbranch_vccz lpd_20
    s_sleep 0
    s_sub_u32 s62, s62, 1
    s_cmp_lg_u32 s62, 0
    s_cbranch_scc1 lp_19
lpd_20:
    ds_read_b128 v[84:87], v7 offset:4096
a_setc:
    ds_read_b128 v[92:95], v3
    ds_read_b128 v[100:103], v12
    ds_read_b128 v[76:79], v12 offset:512
    ds_read_b128 v[96:99], v3 offset:1024
    v_mov_b32 v7, v108
    v_mov_b32 v109, 0xdddddddd
    v_mov_b32 v4, v12
    v_permlane32_swap_b32 v108, v7
    s_nop 0
    v_max_f32 v108, v108, v7
    v_sub_f32 v112, 0x42900000, v108
    v_sub_f32 v113, 0x42900000, v108
    v_pk_add_f32 v[114:115], v[112:113], 0
    v_pk_add_f32 v[116:117], v[112:113], 0
    v_pk_add_f32 v[118:119], v[112:113], 0
    v_pk_add_f32 v[120:121], v[112:113], 0
    v_pk_add_f32 v[122:123], v[112:113], 0
    v_pk_add_f32 v[124:125], v[112:113], 0
    v_pk_add_f32 v[126:127], v[112:113], 0
    s_waitcnt lgkmcnt(3)
    s_mov_b64 vcc, s[28:29]
    v_mfma_f32_32x32x16_bf16 v[16:31], v[92:95], v[84:87], v[112:127]
    v_mfma_f32_32x32x16_bf16 v[48:63], v[152:155], v[88:91], 0
    s_waitcnt lgkmcnt(1)
    v_mov_b32 v1, 0
    s_mov_b32 s22, 1
    s_setprio 1
    s_nop 6
    v_exp_f32 v16, v16
    v_exp_f32 v17, v17
    s_branch a_loop
    .p2align 6
    s_nop 0
a_loop_hi:
    s_setprio 2
a_loop:
    v_exp_f32 v18, v18
    v_exp_f32 v19, v19
    v_mfma_f32_32x32x16_bf16 v[136:151], v[92:95], v[88:91], v[112:127]
    ds_read_b128 v[104:107], v4 offset:1024
    v_exp_f32 v20, v20
    v_exp_f32 v21, v21
    v_exp_f32 v22, v22
    v_exp_f32 v23, v23
    v_exp_f32 v24, v24
    v_exp_f32 v25, v25
    v_smfmac_f32_32x32x32_bf16 v[48:63], v[100:103], v[16:23], v109
    ds_read_b128 v[72:75], v4 offset:1536
    v_exp_f32 v26, v26
    v_exp_f32 v27, v27
    v_exp_f32 v28, v28
    v_exp_f32 v29, v29
    v_exp_f32 v30, v30
    v_exp_f32 v31, v31
    v_exp_f32 v136, v136
    v_exp_f32 v137, v137
    v_smfmac_f32_32x32x32_bf16 v[48:63], v[76:79], v[24:31], v109
    s_waitcnt lgkmcnt(0)
    v_exp_f32 v138, v138
    v_exp_f32 v139, v139
    v_mfma_f32_32x32x16_bf16 v[16:31], v[96:99], v[84:87], v[112:127]
    v_exp_f32 v140, v140
    v_exp_f32 v141, v141
    v_exp_f32 v142, v142
    v_exp_f32 v143, v143
    v_exp_f32 v144, v144
    v_exp_f32 v145, v145
    v_smfmac_f32_32x32x32_bf16 v[152:167], v[100:103], v[136:143], v109
    v_exp_f32 v146, v146
    v_exp_f32 v147, v147
    v_exp_f32 v148, v148
    v_exp_f32 v149, v149
    v_exp_f32 v150, v150
    v_exp_f32 v151, v151
    v_exp_f32 v16, v16
    v_exp_f32 v17, v17
    v_smfmac_f32_32x32x32_bf16 v[152:167], v[76:79], v[144:151], v109
    ds_read_b128 v[92:95], v3 offset:2048
    v_exp_f32 v18, v18
    v_exp_f32 v19, v19
    v_mfma_f32_32x32x16_bf16 v[136:151], v[96:99], v[88:91], v[112:127]
    ds_read_b128 v[100:103], v4 offset:2048
    v_exp_f32 v20, v20
    v_exp_f32 v21, v21
    v_exp_f32 v22, v22
    v_exp_f32 v23, v23
    v_exp_f32 v24, v24
    v_exp_f32 v25, v25
    v_smfmac_f32_32x32x32_bf16 v[48:63], v[104:107], v[16:23], v109
    ds_read_b128 v[76:79], v4 offset:2560
    v_exp_f32 v26, v26
    v_exp_f32 v27, v27
    v_exp_f32 v28, v28
    v_exp_f32 v29, v29
    v_exp_f32 v30, v30
    v_exp_f32 v31, v31
    v_exp_f32 v136, v136
    v_exp_f32 v137, v137
    v_smfmac_f32_32x32x32_bf16 v[48:63], v[72:75], v[24:31], v109
    s_waitcnt lgkmcnt(0)
    v_exp_f32 v138, v138
    v_exp_f32 v139, v139
    v_mfma_f32_32x32x16_bf16 v[16:31], v[92:95], v[84:87], v[112:127]
    v_exp_f32 v140, v140
    v_exp_f32 v141, v141
    v_exp_f32 v142, v142
    v_exp_f32 v143, v143
    v_exp_f32 v144, v144
    v_exp_f32 v145, v145
    v_smfmac_f32_32x32x32_bf16 v[152:167], v[104:107], v[136:143], v109
    ds_read_b128 v[96:99], v3 offset:3072
    v_exp_f32 v146, v146
    v_exp_f32 v147, v147
    v_exp_f32 v148, v148
    v_exp_f32 v149, v149
    v_exp_f32 v150, v150
    v_exp_f32 v151, v151
    v_exp_f32 v16, v16
    v_exp_f32 v17, v17
    v_smfmac_f32_32x32x32_bf16 v[152:167], v[72:75], v[144:151], v109
    v_exp_f32 v18, v18
    v_exp_f32 v19, v19
    s_lshr_b32 s23, s23, 2
    s_cbranch_scc0 a_tail
    v_mfma_f32_32x32x16_bf16 v[136:151], v[92:95], v[88:91], v[112:127]
    ds_read_b128 v[104:107], v4 offset:3072
    v_exp_f32 v20, v20
    v_exp_f32 v21, v21
    v_exp_f32 v22, v22
    v_exp_f32 v23, v23
    v_exp_f32 v24, v24
    v_exp_f32 v25, v25
    v_smfmac_f32_32x32x32_bf16 v[48:63], v[100:103], v[16:23], v109
    ds_read_b128 v[72:75], v4 offset:3584
    v_exp_f32 v26, v26
    v_exp_f32 v27, v27
    v_exp_f32 v28, v28
    v_exp_f32 v29, v29
    v_exp_f32 v30, v30
    v_exp_f32 v31, v31
    v_exp_f32 v136, v136
    v_exp_f32 v137, v137
    v_smfmac_f32_32x32x32_bf16 v[48:63], v[76:79], v[24:31], v109
    s_waitcnt lgkmcnt(0)
    s_setprio 1
    v_add_u32 v4, v5, v4
    v_exp_f32 v138, v138
    v_exp_f32 v139, v139
    v_mfma_f32_32x32x16_bf16 v[16:31], v[96:99], v[84:87], v[112:127]
    v_add_u32 v3, 0x4000, v3
    v_exp_f32 v140, v140
    v_exp_f32 v141, v141
    v_exp_f32 v142, v142
    v_exp_f32 v143, v143
    v_exp_f32 v144, v144
    v_exp_f32 v145, v145
    v_smfmac_f32_32x32x32_bf16 v[152:167], v[100:103], v[136:143], v109
    v_exp_f32 v146, v146
    v_exp_f32 v147, v147
    v_exp_f32 v148, v148
    v_exp_f32 v149, v149
    v_exp_f32 v150, v150
    v_exp_f32 v151, v151
    v_exp_f32 v16, v16
    v_exp_f32 v17, v17
    v_smfmac_f32_32x32x32_bf16 v[152:167], v[76:79], v[144:151], v109
    s_bitcmp1_b32 s23, 0
    s_cbranch_scc1 a_sync
a_syncr:
    ds_read_b128 v[92:95], v3 offset:0
    v_exp_f32 v18, v18
    v_exp_f32 v19, v19
    v_mfma_f32_32x32x16_bf16 v[136:151], v[96:99], v[88:91], v[112:127]
    ds_read_b128 v[100:103], v4 offset:0
    v_exp_f32 v20, v20
    v_exp_f32 v21, v21
    v_exp_f32 v22, v22
    v_exp_f32 v23, v23
    v_exp_f32 v24, v24
    v_exp_f32 v25, v25
    v_smfmac_f32_32x32x32_bf16 v[48:63], v[104:107], v[16:23], v109
    ds_read_b128 v[76:79], v4 offset:512
    v_exp_f32 v26, v26
    v_exp_f32 v27, v27
    v_exp_f32 v28, v28
    v_exp_f32 v29, v29
    v_exp_f32 v30, v30
    v_exp_f32 v31, v31
    v_exp_f32 v136, v136
    v_exp_f32 v137, v137
    v_smfmac_f32_32x32x32_bf16 v[48:63], v[72:75], v[24:31], v109
    s_waitcnt lgkmcnt(0)
    v_exp_f32 v138, v138
    v_exp_f32 v139, v139
    v_mfma_f32_32x32x16_bf16 v[16:31], v[92:95], v[84:87], v[112:127]
    v_exp_f32 v140, v140
    v_exp_f32 v141, v141
    v_exp_f32 v142, v142
    v_exp_f32 v143, v143
    v_exp_f32 v144, v144
    v_exp_f32 v145, v145
    v_smfmac_f32_32x32x32_bf16 v[152:167], v[104:107], v[136:143], v109
    v_exp_f32 v146, v146
    v_exp_f32 v147, v147
    v_exp_f32 v148, v148
    v_exp_f32 v149, v149
    v_exp_f32 v150, v150
    v_exp_f32 v151, v151
    v_exp_f32 v16, v16
    v_exp_f32 v17, v17
    v_smfmac_f32_32x32x32_bf16 v[152:167], v[72:75], v[144:151], v109
    ds_read_b128 v[96:99], v3 offset:1024
    s_cbranch_vccnz a_loop_hi
    s_branch a_loop
a_sync:
    s_cmp_lg_u32 s22, 15
    s_cbranch_scc1 a_sy
    ds_read_b32 v1, v8
    s_cbranch_vccz a_syncr
    s_mov_b64 exec, 1
    ds_add_u32 v14, v15 offset:28
    s_mov_b64 exec, -1
    s_branch a_syncr
a_sy:
    v_and_b32 v7, 3, v0
    v_lshl_add_u32 v7, v7, 2, v14
    v_and_b32 v8, 31, v0
    v_lshl_add_u32 v8, v8, 2, s31
    ds_read_b32 v1, v8
    s_cmp_lg_u32 s22, 3
    s_cbranch_scc1 a_sz
    s_mov_b64 exec, 1
    ds_add_u32 v14, v15 offset:8
    s_mov_b64 exec, -1
    v_add_u32 v128, s45, v2
    v_xor_b32 v129, 0x2000, v128
    v_mov_b32 v131, s46
a_sz:
    s_mov_b32 s62, 131072
lp_21:
    ds_read_b32 v6, v7 offset:160
    s_waitcnt lgkmcnt(0)
    v_cmp_gt_u32 vcc, s22, v6
    s_cbranch_vccz lpd_22
    s_sleep 1
    s_sub_u32 s62, s62, 1
    s_cmp_lg_u32 s62, 0
    s_cbranch_scc1 lp_21
lpd_22:
    s_lshl1_add_u32 s22, s22, 1
    s_mov_b64 vcc, s[28:29]
    s_branch a_syncr
a_xw:
    s_mov_b32 s62, 131072
lp_23:
    ds_read_b32 v6, v131 offset:0
    s_waitcnt lgkmcnt(0)
    v_cmp_gt_u32 vcc, 8, v6
    s_cbranch_vccz lpd_24
    s_sleep 2
    s_sub_u32 s62, s62, 1
    s_cmp_lg_u32 s62, 0
    s_cbranch_scc1 lp_23
lpd_24:
    s_branch a_xwr
a_xr:
    s_sleep 0
    ds_read_b32 v6, v130 offset:208
    ds_read_b128 v[48:51], v129 offset:0
    ds_read_b128 v[52:55], v129 offset:1024
    ds_read2st64_b32 v[56:57], v129 offset0:16 offset1:20
    s_sub_u32 s62, s62, 1
    s_cbranch_scc0 a_gq
    s_waitcnt lgkmcnt(0)
    s_branch a_xd
a_tail:
    s_waitcnt lgkmcnt(0)
    v_mfma_f32_32x32x16_bf16 v[136:151], v[96:99], v[84:87], v[112:127]
    ds_read_b128 v[104:107], v4 offset:3072
    ds_read_b32 v6, v131
    ds_read_b128 v[72:75], v4 offset:3584
    v_exp_f32 v20, v20
    v_exp_f32 v21, v21
    v_exp_f32 v22, v22
    v_exp_f32 v23, v23
    v_exp_f32 v24, v24
    v_exp_f32 v25, v25
    v_smfmac_f32_32x32x32_bf16 v[48:63], v[100:103], v[16:23], v109
    v_exp_f32 v26, v26
    v_exp_f32 v27, v27
    v_exp_f32 v28, v28
    v_exp_f32 v29, v29
    v_exp_f32 v30, v30
    v_exp_f32 v31, v31
    v_exp_f32 v136, v136
    v_exp_f32 v137, v137
    v_smfmac_f32_32x32x32_bf16 v[48:63], v[76:79], v[24:31], v109
    s_waitcnt lgkmcnt(0)
    v_cmp_gt_u32 vcc, 8, v6
    s_cbranch_vccnz a_xw
a_xwr:
    s_setprio 1
    v_exp_f32 v138, v138
    v_exp_f32 v139, v139
    v_mfma_f32_32x32x16_bf16 v[16:31], v[92:95], v[88:91], v[112:127]
    v_exp_f32 v140, v140
    v_exp_f32 v141, v141
    v_exp_f32 v142, v142
    v_exp_f32 v143, v143
    v_exp_f32 v144, v144
    v_exp_f32 v145, v145
    v_smfmac_f32_32x32x32_bf16 v[48:63], v[104:107], v[136:143], v109
    v_exp_f32 v146, v146
    v_exp_f32 v147, v147
    v_exp_f32 v148, v148
    v_exp_f32 v149, v149
    v_exp_f32 v150, v150
    v_exp_f32 v151, v151
    v_exp_f32 v16, v16
    v_exp_f32 v17, v17
    v_smfmac_f32_32x32x32_bf16 v[48:63], v[72:75], v[144:151], v109
    v_exp_f32 v18, v18
    v_exp_f32 v19, v19
    v_mfma_f32_32x32x16_bf16 v[136:151], v[96:99], v[88:91], v[112:127]
    v_exp_f32 v20, v20
    v_exp_f32 v21, v21
    v_exp_f32 v22, v22
    v_exp_f32 v23, v23
    v_exp_f32 v24, v24
    v_exp_f32 v25, v25
    v_smfmac_f32_32x32x32_bf16 v[152:167], v[100:103], v[16:23], v109
    v_exp_f32 v26, v26
    v_exp_f32 v27, v27
    ds_write_b128 v128, v[48:51] offset:0
    v_exp_f32 v28, v28
    v_exp_f32 v29, v29
    ds_write_b128 v128, v[52:55] offset:1024
    v_exp_f32 v30, v30
    ds_write2st64_b32 v128, v56, v108 offset0:16 offset1:20
    ds_write_b32 v13, v15 offset:208
    v_exp_f32 v31, v31
    v_exp_f32 v136, v136
    v_exp_f32 v137, v137
    v_smfmac_f32_32x32x32_bf16 v[152:167], v[76:79], v[24:31], v109
    v_exp_f32 v138, v138
    v_exp_f32 v139, v139
    v_exp_f32 v140, v140
    v_exp_f32 v141, v141
    v_exp_f32 v142, v142
    v_exp_f32 v143, v143
    ds_read_b32 v6, v130 offset:208
    ds_read_b128 v[48:51], v129 offset:0
    ds_read_b128 v[52:55], v129 offset:1024
    ds_read2st64_b32 v[56:57], v129 offset0:16 offset1:20
    v_exp_f32 v144, v144
    v_exp_f32 v145, v145
    v_smfmac_f32_32x32x32_bf16 v[152:167], v[104:107], v[136:143], v109
    v_exp_f32 v146, v146
    v_exp_f32 v147, v147
    v_exp_f32 v148, v148
    v_exp_f32 v149, v149
    v_exp_f32 v150, v150
    v_exp_f32 v151, v151
    v_cmp_le_i32 vcc, 0, v1
    s_mov_b32 s62, 131072
    v_smfmac_f32_32x32x32_bf16 v[152:167], v[72:75], v[144:151], v109
a_fin:
    s_mov_b32 s12, s30
    s_mov_b32 s22, 0x42200000
    s_cbranch_vccz a_gq
a_gp:
    ds_read_b32 v1, v8
    s_waitcnt lgkmcnt(0)
    v_cmp_le_i32 vcc, 0, v1
    s_cbranch_vccz a_gq
    s_sleep 2
    s_sub_u32 s62, s62, 1
    s_cmp_lg_u32 s62, 0
    s_cbranch_scc1 a_gp
a_gq:
    s_waitcnt lgkmcnt(0)
    v_cmp_eq_u32 vcc, 0, v6
    s_cbranch_vccnz a_xr
a_xd:
    v_sub_f32 v6, v57, v108
    v_exp_f32 v7, v6
    v_cmp_nlt_f32 s[46:47], |v6|, s22
    s_nop 2
    v_fmac_f32 v160, v56, v7
    v_fmac_f32 v152, v48, v7
    v_fmac_f32 v153, v49, v7
    v_fmac_f32 v154, v50, v7
    v_fmac_f32 v155, v51, v7
    v_fmac_f32 v156, v52, v7
    v_fmac_f32 v157, v53, v7
    v_fmac_f32 v158, v54, v7
    v_fmac_f32 v159, v55, v7
a_gpd:
    v_mov_b32 v161, v160
    v_add_f32 v6, |v152|, |v153|
    v_add_f32 v7, |v154|, |v155|
    v_permlane32_swap_b32 v160, v161
    s_cmp_lg_u32 s20, 0
    s_cbranch_scc1 a_done
    s_mov_b32 s22, 0x71800000
    v_cmp_nlt_f32 s[24:25], v160, s22
    s_movk_i32 s23, 0x207
    v_add_f32 v6, v6, |v156|
    v_add_f32 v7, v7, |v157|
    v_add_f32 v6, v6, |v158|
    v_add_f32 v7, v7, |v159|
    v_add_f32 v6, v6, v7
    v_cmp_class_f32 s[26:27], v6, s23
    s_or_b64 s[24:25], s[24:25], s[26:27]
    s_or_b64 s[24:25], s[24:25], s[46:47]
    s_cmp_eq_u64 s[24:25], 0
    s_cbranch_scc1 a_done
a_fb:
    s_mov_b32 s20, 1
    s_lshl_b32 s24, s88, 17
    s_add_u32 s24, s24, 20971520
    v_mov_b32 v108, 0xff800000
    ds_read_b128 v[100:103], v12
    ds_read_b128 v[76:79], v12 offset:512
    v_bfe_u32 v6, v0, 4, 1
    v_cmp_eq_u32 s[26:27], 0, v6
    s_mov_b32 s21, 0
    s_mov_b32 s25, s24
a_maxloop:
    buffer_load_dwordx4 v[92:95], v2, s[40:43], s25 offen sc1
    s_waitcnt vmcnt(0)
    v_mfma_f32_32x32x16_bf16 v[16:31], v[92:95], v[88:91], 0
    s_nop 15
    s_nop 3
    v_max3_f32 v108, v108, v16, v17
    v_max3_f32 v108, v108, v18, v19
    v_max3_f32 v108, v108, v20, v21
    v_max3_f32 v108, v108, v22, v23
    v_max3_f32 v108, v108, v24, v25
    v_max3_f32 v108, v108, v26, v27
    v_max3_f32 v108, v108, v28, v29
    v_max3_f32 v108, v108, v30, v31
    s_add_u32 s21, s21, 1
    s_and_b32 s22, s21, 3
    s_cmp_eq_u32 s22, 0
    s_movk_i32 s23, 1024
    s_cselect_b32 s22, 5120, s23
    s_add_u32 s25, s25, s22
    s_cmp_lt_u32 s21, 64
    s_cbranch_scc1 a_maxloop
    v_mov_b32 v7, v108
    v_pk_mul_f32 v[152:153], 0, 0
    v_pk_mul_f32 v[154:155], 0, 0
    v_pk_mul_f32 v[156:157], 0, 0
    v_pk_mul_f32 v[158:159], 0, 0
    v_pk_mul_f32 v[160:161], 0, 0
    v_pk_mul_f32 v[162:163], 0, 0
    v_pk_mul_f32 v[164:165], 0, 0
    v_pk_mul_f32 v[166:167], 0, 0
    v_permlane32_swap_b32 v108, v7
    s_nop 1
    v_max_f32 v108, v108, v7
    v_sub_f32 v112, 0, v108
    v_sub_f32 v113, 0, v108
    v_sub_f32 v114, 0, v108
    v_sub_f32 v115, 0, v108
    v_sub_f32 v116, 0, v108
    v_sub_f32 v117, 0, v108
    v_sub_f32 v118, 0, v108
    v_sub_f32 v119, 0, v108
    v_sub_f32 v120, 0, v108
    v_sub_f32 v121, 0, v108
    v_sub_f32 v122, 0, v108
    v_sub_f32 v123, 0, v108
    v_sub_f32 v124, 0, v108
    v_sub_f32 v125, 0, v108
    v_sub_f32 v126, 0, v108
    v_sub_f32 v127, 0, v108
    s_mov_b32 s21, 0
    s_mov_b32 s25, s24
    s_waitcnt lgkmcnt(0)
a_fbloop:
    buffer_load_dwordx4 v[92:95], v2, s[40:43], s25 offen sc1
    s_sub_u32 s45, s25, s44
    s_mov_b64 exec, s[26:27]
    buffer_load_dwordx4 v[100:103], v12, s[40:43], s45 offen sc1
    buffer_load_dwordx4 v[76:79], v12, s[40:43], s45 offen offset:512 sc1
    s_mov_b64 exec, -1
    s_waitcnt vmcnt(0)
    v_mfma_f32_32x32x16_bf16 v[16:31], v[92:95], v[88:91], v[112:127]
    s_nop 15
    s_nop 3
    v_exp_f32 v16, v16
    v_exp_f32 v17, v17
    v_exp_f32 v18, v18
    v_exp_f32 v19, v19
    v_exp_f32 v20, v20
    v_exp_f32 v21, v21
    v_exp_f32 v22, v22
    v_exp_f32 v23, v23
    v_exp_f32 v24, v24
    v_exp_f32 v25, v25
    v_exp_f32 v26, v26
    v_exp_f32 v27, v27
    v_exp_f32 v28, v28
    v_exp_f32 v29, v29
    v_exp_f32 v30, v30
    v_exp_f32 v31, v31
    s_nop 3
    v_smfmac_f32_32x32x32_bf16 v[152:167], v[100:103], v[16:23], v109
    v_smfmac_f32_32x32x32_bf16 v[152:167], v[76:79], v[24:31], v109
    s_nop 15
    s_nop 15
    s_add_u32 s21, s21, 1
    s_and_b32 s22, s21, 3
    s_cmp_eq_u32 s22, 0
    s_movk_i32 s23, 1024
    s_cselect_b32 s22, 5120, s23
    s_add_u32 s25, s25, s22
    s_cmp_lt_u32 s21, 64
    s_cbranch_scc1 a_fbloop
    s_branch a_gpd
y_p1:
    v_mov_b32 v13, s22
    v_add_u32 v11, s9, v2
    s_cmp_eq_u32 s89, 7
    s_cbranch_scc1 i_p1
    v_lshrrev_b32 v3, 5, v0
    v_and_b32 v4, 31, v0
    v_xor_b32 v9, v9, v3
    v_lshlrev_b32 v9, 4, v9
    v_lshl_add_u32 v4, v4, 7, v9
    v_add_u32 v4, s10, v4
    v_xor_b32 v5, 32, v4
    v_xor_b32 v6, 64, v4
    v_xor_b32 v7, 96, v4
    v_lshl_add_u32 v8, v3, 10, v8
    v_add_u32 v8, 90112, v8
    v_xor_b32 v9, 64, v8
    v_lshlrev_b32 v3, 3, v3
    v_add_u32 v3, 147456, v3
    s_waitcnt lgkmcnt(0)
    s_barrier
    ds_read2_b64 v[136:139], v3 offset0:0 offset1:2
    ds_read2_b64 v[140:143], v3 offset0:4 offset1:6
    ds_read2_b64 v[144:147], v3 offset0:8 offset1:10
    ds_read2_b64 v[148:151], v3 offset0:12 offset1:14
    ds_read_b64_tr_b16 v[112:113], v8 offset:0
    ds_read_b64_tr_b16 v[114:115], v8 offset:512
    ds_read_b128 v[80:83], v4 offset:0
    ds_read_b128 v[84:87], v4 offset:4096
    ds_read_b64_tr_b16 v[116:117], v9 offset:0
    ds_read_b64_tr_b16 v[118:119], v9 offset:512
    ds_read_b64_tr_b16 v[120:121], v8 offset:2048
    ds_read_b64_tr_b16 v[122:123], v8 offset:2560
    s_waitcnt lgkmcnt(11)
    v_lshlrev_b32 v16, 16, v136
    v_and_b32 v17, 0xffff0000, v136
    v_lshlrev_b32 v18, 16, v137
    v_and_b32 v19, 0xffff0000, v137
    v_mov_b64 v[32:33], v[16:17]
    v_mov_b64 v[34:35], v[18:19]
    v_lshlrev_b32 v20, 16, v138
    v_and_b32 v21, 0xffff0000, v138
    v_lshlrev_b32 v22, 16, v139
    v_and_b32 v23, 0xffff0000, v139
    v_mov_b64 v[36:37], v[20:21]
    v_mov_b64 v[38:39], v[22:23]
    s_waitcnt lgkmcnt(10)
    v_lshlrev_b32 v24, 16, v140
    v_and_b32 v25, 0xffff0000, v140
    v_lshlrev_b32 v26, 16, v141
    v_and_b32 v27, 0xffff0000, v141
    v_mov_b64 v[40:41], v[24:25]
    v_mov_b64 v[42:43], v[26:27]
    v_lshlrev_b32 v28, 16, v142
    v_and_b32 v29, 0xffff0000, v142
    v_lshlrev_b32 v30, 16, v143
    v_and_b32 v31, 0xffff0000, v143
    v_mov_b64 v[44:45], v[28:29]
    v_mov_b64 v[46:47], v[30:31]
    s_waitcnt lgkmcnt(9)
    v_lshlrev_b32 v48, 16, v144
    v_and_b32 v49, 0xffff0000, v144
    v_lshlrev_b32 v50, 16, v145
    v_and_b32 v51, 0xffff0000, v145
    v_mov_b64 v[64:65], v[48:49]
    v_mov_b64 v[66:67], v[50:51]
    v_lshlrev_b32 v52, 16, v146
    v_and_b32 v53, 0xffff0000, v146
    v_lshlrev_b32 v54, 16, v147
    v_and_b32 v55, 0xffff0000, v147
    v_mov_b64 v[68:69], v[52:53]
    v_mov_b64 v[70:71], v[54:55]
    s_waitcnt lgkmcnt(8)
    v_lshlrev_b32 v56, 16, v148
    v_and_b32 v57, 0xffff0000, v148
    v_lshlrev_b32 v58, 16, v149
    v_and_b32 v59, 0xffff0000, v149
    v_mov_b64 v[72:73], v[56:57]
    v_mov_b64 v[74:75], v[58:59]
    v_lshlrev_b32 v60, 16, v150
    v_and_b32 v61, 0xffff0000, v150
    v_lshlrev_b32 v62, 16, v151
    v_and_b32 v63, 0xffff0000, v151
    v_mov_b64 v[76:77], v[60:61]
    v_mov_b64 v[78:79], v[62:63]
    s_nop 0
y_l1:
    s_bitcmp1_b32 s15, s63
    s_cselect_b32 s10, 4294868992, s14
    s_waitcnt lgkmcnt(5)
    v_mfma_f32_32x32x16_bf16 v[16:31], v[112:115], v[80:83], v[16:31]
    ds_read_b128 v[88:91], v5 offset:0
    ds_read_b128 v[92:95], v5 offset:4096
    s_waitcnt lgkmcnt(6)
    v_mfma_f32_32x32x16_bf16 v[32:47], v[112:115], v[84:87], v[32:47]
    ds_read_b64_tr_b16 v[124:125], v9 offset:2048
    ds_read_b64_tr_b16 v[126:127], v9 offset:2560
    s_waitcnt lgkmcnt(6)
    v_mfma_f32_32x32x16_bf16 v[48:63], v[116:119], v[80:83], v[48:63]
    ds_read_b64_tr_b16 v[128:129], v8 offset:4096
    ds_read_b64_tr_b16 v[130:131], v8 offset:4608
    v_mfma_f32_32x32x16_bf16 v[64:79], v[116:119], v[84:87], v[64:79]
    ds_read_b128 v[96:99], v6 offset:0
    ds_read_b128 v[100:103], v6 offset:4096
    s_waitcnt lgkmcnt(6)
    v_mfma_f32_32x32x16_bf16 v[16:31], v[120:123], v[88:91], v[16:31]
    ds_read_b64_tr_b16 v[132:133], v9 offset:4096
    ds_read_b64_tr_b16 v[134:135], v9 offset:4608
    v_mfma_f32_32x32x16_bf16 v[32:47], v[120:123], v[92:95], v[32:47]
    ds_read_b64_tr_b16 v[136:137], v8 offset:6144
    ds_read_b64_tr_b16 v[138:139], v8 offset:6656
    s_waitcnt lgkmcnt(8)
    v_mfma_f32_32x32x16_bf16 v[48:63], v[124:127], v[88:91], v[48:63]
    ds_read_b128 v[104:107], v7 offset:0
    ds_read_b128 v[108:111], v7 offset:4096
    v_mfma_f32_32x32x16_bf16 v[64:79], v[124:127], v[92:95], v[64:79]
    ds_read_b64_tr_b16 v[140:141], v9 offset:6144
    ds_read_b64_tr_b16 v[142:143], v9 offset:6656
    s_waitcnt lgkmcnt(6)
    v_mfma_f32_32x32x16_bf16 v[16:31], v[128:131], v[96:99], v[16:31]
    v_mfma_f32_32x32x16_bf16 v[32:47], v[128:131], v[100:103], v[32:47]
    v_mfma_f32_32x32x16_bf16 v[48:63], v[132:135], v[96:99], v[48:63]
    v_mfma_f32_32x32x16_bf16 v[64:79], v[132:135], v[100:103], v[64:79]
    s_add_u32 s63, s63, 4
    s_cmp_eq_u32 s63, 36
    s_waitcnt vmcnt(0) lgkmcnt(0)
    v_add_u32 v8, s10, v8
    v_add_u32 v4, s10, v4
    v_add_u32 v9, s10, v9
    v_add_u32 v5, s10, v5
    v_add_u32 v6, s10, v6
    v_add_u32 v7, s10, v7
    s_cbranch_scc1 y_last
    s_barrier
    v_mfma_f32_32x32x16_bf16 v[16:31], v[136:139], v[104:107], v[16:31]
    ds_read_b64_tr_b16 v[112:113], v8 offset:0
    ds_read_b64_tr_b16 v[114:115], v8 offset:512
    v_mfma_f32_32x32x16_bf16 v[32:47], v[136:139], v[108:111], v[32:47]
    ds_read_b128 v[80:83], v4 offset:0
    ds_read_b128 v[84:87], v4 offset:4096
    v_mfma_f32_32x32x16_bf16 v[48:63], v[140:143], v[104:107], v[48:63]
    ds_read_b64_tr_b16 v[116:117], v9 offset:0
    ds_read_b64_tr_b16 v[118:119], v9 offset:512
    v_mfma_f32_32x32x16_bf16 v[64:79], v[140:143], v[108:111], v[64:79]
    ds_read_b64_tr_b16 v[120:121], v8 offset:2048
    ds_read_b64_tr_b16 v[122:123], v8 offset:2560
    s_branch y_l1
y_last:
    v_mfma_f32_32x32x16_bf16 v[16:31], v[136:139], v[104:107], v[16:31]
    v_mfma_f32_32x32x16_bf16 v[32:47], v[136:139], v[108:111], v[32:47]
    v_mfma_f32_32x32x16_bf16 v[48:63], v[140:143], v[104:107], v[48:63]
    v_mfma_f32_32x32x16_bf16 v[64:79], v[140:143], v[108:111], v[64:79]
y_ep:
    s_setprio 2
    v_add_u32 v6, s21, v2
    v_add_u32 v3, s8, v2
    v_mov_b32 v5, 0x4000
    v_cndmask_b32 v5, v5, 0, s[12:13]
    v_and_b32 v8, 7, v0
    v_lshl_add_u32 v8, v8, 2, v14
    v_xor_b32 v130, 16, v13
    v_cndmask_b32 v10, v13, v130, s[12:13]
    v_xor_b32 v9, 0x800, v6
    s_nop 2
    v_max_f32 v16, 0, v16
    v_max_f32 v17, 0, v17
    v_max_f32 v18, 0, v18
    v_max_f32 v19, 0, v19
    v_max_f32 v20, 0, v20
    v_max_f32 v21, 0, v21
    v_max_f32 v22, 0, v22
    v_max_f32 v23, 0, v23
    v_max_f32 v24, 0, v24
    v_max_f32 v25, 0, v25
    v_max_f32 v26, 0, v26
    v_max_f32 v27, 0, v27
    v_max_f32 v28, 0, v28
    v_max_f32 v29, 0, v29
    v_max_f32 v30, 0, v30
    v_max_f32 v31, 0, v31
    v_pk_mul_f32 v[16:17], v[16:17], v[16:17]
    v_pk_mul_f32 v[18:19], v[18:19], v[18:19]
    v_pk_mul_f32 v[20:21], v[20:21], v[20:21]
    v_pk_mul_f32 v[22:23], v[22:23], v[22:23]
    v_pk_mul_f32 v[24:25], v[24:25], v[24:25]
    v_pk_mul_f32 v[26:27], v[26:27], v[26:27]
    v_pk_mul_f32 v[28:29], v[28:29], v[28:29]
    v_pk_mul_f32 v[30:31], v[30:31], v[30:31]
    v_cvt_pk_bf16_f32 v16, v16, v17
    v_cvt_pk_bf16_f32 v17, v18, v19
    v_cvt_pk_bf16_f32 v18, v24, v25
    v_cvt_pk_bf16_f32 v19, v26, v27
    v_cvt_pk_bf16_f32 v20, v20, v21
    v_cvt_pk_bf16_f32 v21, v22, v23
    v_cvt_pk_bf16_f32 v22, v28, v29
    v_cvt_pk_bf16_f32 v23, v30, v31
    ds_write_b128 v11, v[16:19] offset:0
    ds_write_b128 v11, v[20:23] offset:1024
    s_mov_b32 s62, 131072
lp_25:
    ds_read_b32 v7, v10 offset:172
    s_waitcnt lgkmcnt(0)
    v_cmp_gt_u32 vcc, 1, v7
    s_cbranch_vccz lpd_26
    s_sleep 0
    s_sub_u32 s62, s62, 1
    s_cmp_lg_u32 s62, 0
    s_cbranch_scc1 lp_25
lpd_26:
    ds_read_b128 v[88:91], v6
    ds_read_b128 v[92:95], v3
    ds_read_b128 v[84:87], v9
    v_max_f32 v32, 0, v32
    v_max_f32 v33, 0, v33
    v_max_f32 v34, 0, v34
    v_max_f32 v35, 0, v35
    v_max_f32 v36, 0, v36
    v_max_f32 v37, 0, v37
    v_max_f32 v38, 0, v38
    v_max_f32 v39, 0, v39
    v_max_f32 v40, 0, v40
    v_max_f32 v41, 0, v41
    v_max_f32 v42, 0, v42
    v_max_f32 v43, 0, v43
    v_max_f32 v44, 0, v44
    v_max_f32 v45, 0, v45
    v_max_f32 v46, 0, v46
    v_max_f32 v47, 0, v47
    v_pk_mul_f32 v[32:33], v[32:33], v[32:33]
    v_pk_mul_f32 v[34:35], v[34:35], v[34:35]
    v_pk_mul_f32 v[36:37], v[36:37], v[36:37]
    v_pk_mul_f32 v[38:39], v[38:39], v[38:39]
    v_pk_mul_f32 v[40:41], v[40:41], v[40:41]
    v_pk_mul_f32 v[42:43], v[42:43], v[42:43]
    v_pk_mul_f32 v[44:45], v[44:45], v[44:45]
    v_pk_mul_f32 v[46:47], v[46:47], v[46:47]
    v_cvt_pk_bf16_f32 v32, v32, v33
    v_cvt_pk_bf16_f32 v33, v34, v35
    v_cvt_pk_bf16_f32 v34, v40, v41
    v_cvt_pk_bf16_f32 v35, v42, v43
    v_cvt_pk_bf16_f32 v36, v36, v37
    v_cvt_pk_bf16_f32 v37, v38, v39
    v_cvt_pk_bf16_f32 v38, v44, v45
    v_cvt_pk_bf16_f32 v39, v46, v47
    ds_write_b128 v11, v[32:35] offset:4096
    ds_write_b128 v11, v[36:39] offset:5120
    s_waitcnt lgkmcnt(2)
    v_mfma_f32_32x32x16_bf16 v[136:151], v[92:95], v[88:91], 0
    v_max_f32 v48, 0, v48
    v_max_f32 v49, 0, v49
    v_max_f32 v50, 0, v50
    v_max_f32 v51, 0, v51
    v_max_f32 v52, 0, v52
    v_max_f32 v53, 0, v53
    v_max_f32 v54, 0, v54
    v_max_f32 v55, 0, v55
    v_max_f32 v56, 0, v56
    v_max_f32 v57, 0, v57
    v_max_f32 v58, 0, v58
    v_max_f32 v59, 0, v59
    v_max_f32 v60, 0, v60
    v_max_f32 v61, 0, v61
    v_max_f32 v62, 0, v62
    v_max_f32 v63, 0, v63
    v_pk_mul_f32 v[48:49], v[48:49], v[48:49]
    v_pk_mul_f32 v[50:51], v[50:51], v[50:51]
    v_pk_mul_f32 v[52:53], v[52:53], v[52:53]
    v_pk_mul_f32 v[54:55], v[54:55], v[54:55]
    v_pk_mul_f32 v[56:57], v[56:57], v[56:57]
    v_pk_mul_f32 v[58:59], v[58:59], v[58:59]
    v_pk_mul_f32 v[60:61], v[60:61], v[60:61]
    v_pk_mul_f32 v[62:63], v[62:63], v[62:63]
    v_cvt_pk_bf16_f32 v48, v48, v49
    v_cvt_pk_bf16_f32 v49, v50, v51
    v_cvt_pk_bf16_f32 v50, v56, v57
    v_cvt_pk_bf16_f32 v51, v58, v59
    v_cvt_pk_bf16_f32 v52, v52, v53
    v_cvt_pk_bf16_f32 v53, v54, v55
    v_cvt_pk_bf16_f32 v54, v60, v61
    v_cvt_pk_bf16_f32 v55, v62, v63
    ds_write_b128 v11, v[48:51] offset:2048
    ds_write_b128 v11, v[52:55] offset:3072
    v_max_f32 v64, 0, v64
    v_max_f32 v65, 0, v65
    v_max_f32 v66, 0, v66
    v_max_f32 v67, 0, v67
    v_max_f32 v68, 0, v68
    v_max_f32 v69, 0, v69
    v_max_f32 v70, 0, v70
    v_max_f32 v71, 0, v71
    v_max_f32 v72, 0, v72
    v_max_f32 v73, 0, v73
    v_max_f32 v74, 0, v74
    v_max_f32 v75, 0, v75
    v_max_f32 v76, 0, v76
    v_max_f32 v77, 0, v77
    v_max_f32 v78, 0, v78
    v_max_f32 v79, 0, v79
    v_pk_mul_f32 v[64:65], v[64:65], v[64:65]
    v_pk_mul_f32 v[66:67], v[66:67], v[66:67]
    v_pk_mul_f32 v[68:69], v[68:69], v[68:69]
    v_pk_mul_f32 v[70:71], v[70:71], v[70:71]
    v_pk_mul_f32 v[72:73], v[72:73], v[72:73]
    v_pk_mul_f32 v[74:75], v[74:75], v[74:75]
    v_pk_mul_f32 v[76:77], v[76:77], v[76:77]
    v_pk_mul_f32 v[78:79], v[78:79], v[78:79]
    v_cvt_pk_bf16_f32 v64, v64, v65
    v_cvt_pk_bf16_f32 v65, v66, v67
    v_cvt_pk_bf16_f32 v66, v72, v73
    v_cvt_pk_bf16_f32 v67, v74, v75
    v_cvt_pk_bf16_f32 v68, v68, v69
    v_cvt_pk_bf16_f32 v69, v70, v71
    v_cvt_pk_bf16_f32 v70, v76, v77
    v_cvt_pk_bf16_f32 v71, v78, v79
    ds_write_b128 v11, v[64:67] offset:6144
    ds_write_b128 v11, v[68:71] offset:7168
y_hd:
    ds_write2_b32 v13, v15, v15 offset0:15 offset1:16
    v_max3_f32 v108, v136, v137, v138
    v_max3_f32 v108, v108, v139, v140
    v_max3_f32 v108, v108, v141, v142
    v_max3_f32 v108, v108, v143, v144
    v_max3_f32 v108, v108, v145, v146
    v_max3_f32 v108, v108, v147, v148
    v_max3_f32 v108, v108, v149, v150
    v_max_f32 v108, v108, v151
    v_add_u32 v3, s44, v2
    s_mov_b32 s62, 131072
lp_27:
    ds_read_b32 v6, v8 offset:32
    s_waitcnt lgkmcnt(0)
    v_cmp_gt_u32 vcc, 1, v6
    s_cbranch_vccz lpd_28
    s_sleep 0
    s_sub_u32 s62, s62, 1
    s_cmp_lg_u32 s62, 0
    s_cbranch_scc1 lp_27
lpd_28:
    s_branch a_setc
i_p1:
    v_and_b32 v76, 15, v0
    v_cmp_eq_u32 vcc, 0, v76
    v_mov_b32 v76, 159760
    v_and_b32 v77, 48, v0
    v_add_u32 v77, 147456, v77
    v_cndmask_b32 v77, v76, v77, vcc
    v_mov_b32 v76, 128
    v_cndmask_b32 v78, 0, v76, vcc
    s_and_b32 s11, s58, 7
    v_mad_u32_u24 v76, s11, v78, v77
    v_pk_mul_f32 v[16:17], 0, 0
    v_pk_mul_f32 v[18:19], 0, 0
    v_pk_mul_f32 v[20:21], 0, 0
    v_pk_mul_f32 v[22:23], 0, 0
    v_pk_mul_f32 v[24:25], 0, 0
    v_pk_mul_f32 v[26:27], 0, 0
    v_pk_mul_f32 v[28:29], 0, 0
    v_pk_mul_f32 v[30:31], 0, 0
    s_waitcnt lgkmcnt(0)
    s_barrier
    ds_read_b128 v[64:67], v76 offset:0
    ds_read_b128 v[112:115], v4 offset:0
    ds_read_b128 v[116:119], v4 offset:2048
    ds_read_b128 v[120:123], v4 offset:4096
i_l1:
    s_bitcmp1_b32 s15, s63
    s_cselect_b32 s10, 4294868992, s14
    s_lshr_b32 s11, s58, s63
    s_and_b32 s11, s11, 7
    s_waitcnt lgkmcnt(2)
    v_mfma_f32_16x16x32_bf16 v[16:19], v[64:67], v[112:115], v[16:19]
    ds_read_b128 v[124:127], v4 offset:6144
    ds_read_b128 v[68:71], v76 offset:64
    s_waitcnt lgkmcnt(3)
    v_mfma_f32_16x16x32_bf16 v[20:23], v[64:67], v[116:119], v[20:23]
    ds_read_b128 v[128:131], v5 offset:0
    ds_read_b128 v[132:135], v5 offset:2048
    s_waitcnt lgkmcnt(4)
    v_mfma_f32_16x16x32_bf16 v[24:27], v[64:67], v[120:123], v[24:27]
    ds_read_b128 v[136:139], v5 offset:4096
    ds_read_b128 v[140:143], v5 offset:6144
    s_waitcnt lgkmcnt(5)
    v_mfma_f32_16x16x32_bf16 v[28:31], v[64:67], v[124:127], v[28:31]
    s_waitcnt lgkmcnt(3)
    v_mfma_f32_16x16x32_bf16 v[16:19], v[68:71], v[128:131], v[16:19]
    s_waitcnt lgkmcnt(2)
    v_mfma_f32_16x16x32_bf16 v[20:23], v[68:71], v[132:135], v[20:23]
    s_add_u32 s63, s63, 4
    s_cmp_eq_u32 s63, 36
    s_waitcnt vmcnt(0) lgkmcnt(0)
    v_mad_u32_u24 v76, s11, v78, v77
    v_add_u32 v4, s10, v4
    v_add_u32 v5, s10, v5
    s_cbranch_scc1 i_last
    s_barrier
    v_mfma_f32_16x16x32_bf16 v[24:27], v[68:71], v[136:139], v[24:27]
    ds_read_b128 v[64:67], v76 offset:0
    ds_read_b128 v[112:115], v4 offset:0
    v_mfma_f32_16x16x32_bf16 v[28:31], v[68:71], v[140:143], v[28:31]
    ds_read_b128 v[116:119], v4 offset:2048
    ds_read_b128 v[120:123], v4 offset:4096
    s_branch i_l1
i_last:
    v_mfma_f32_16x16x32_bf16 v[24:27], v[68:71], v[136:139], v[24:27]
    v_mfma_f32_16x16x32_bf16 v[28:31], v[68:71], v[140:143], v[28:31]
    v_add_u32 v6, s21, v2
    v_add_u32 v3, s8, v2
    v_mov_b32 v5, 0x4000
    v_cndmask_b32 v5, v5, 0, s[12:13]
    v_and_b32 v8, 7, v0
    v_lshl_add_u32 v8, v8, 2, v14
    v_xor_b32 v130, 16, v13
    v_cndmask_b32 v10, v13, v130, s[12:13]
    v_xor_b32 v9, 0x800, v6
    s_mov_b32 s62, 131072
lp_29:
    ds_read_b32 v7, v10 offset:172
    s_waitcnt lgkmcnt(0)
    v_cmp_gt_u32 vcc, 1, v7
    s_cbranch_vccz lpd_30
    s_sleep 0
    s_sub_u32 s62, s62, 1
    s_cmp_lg_u32 s62, 0
    s_cbranch_scc1 lp_29
lpd_30:
    ds_read_b128 v[88:91], v6
    ds_read_b128 v[92:95], v3
    ds_read_b128 v[84:87], v9
    s_mov_b32 s10, 0xbfb8aa3b
    v_lshlrev_b32 v6, 2, v0
    v_add_u32 v6, s9, v6
    v_add_u32 v7, 4096, v6
    v_mul_f32 v16, s10, v16
    v_mul_f32 v20, s10, v20
    v_mul_f32 v24, s10, v24
    v_mul_f32 v28, s10, v28
    v_exp_f32 v16, v16
    v_exp_f32 v20, v20
    v_exp_f32 v24, v24
    v_exp_f32 v28, v28
    s_waitcnt lgkmcnt(0)
    v_mfma_f32_32x32x16_bf16 v[136:151], v[92:95], v[88:91], 0
    v_add_f32 v16, 1.0, v16
    v_add_f32 v20, 1.0, v20
    v_add_f32 v24, 1.0, v24
    v_add_f32 v28, 1.0, v28
    v_rcp_f32 v16, v16
    v_rcp_f32 v20, v20
    v_rcp_f32 v24, v24
    v_rcp_f32 v28, v28
    s_nop 0
    v_or_b32 v16, 0x80000000, v16
    v_or_b32 v20, 0x80000000, v20
    v_or_b32 v24, 0x80000000, v24
    v_or_b32 v28, 0x80000000, v28
    s_mov_b64 exec, 0xffff
    ds_write2_b32 v6, v16, v20 offset1:16
    ds_write2_b32 v7, v24, v28 offset1:16
    s_mov_b64 exec, -1
    s_branch y_hd
a_done:
    v_rcp_f32 v6, v160
    s_nop 0
a_done2:
    v_mul_f32 v6, v6, |v1|
    v_mul_f32 v152, v152, v6
    v_mul_f32 v153, v153, v6
    v_mul_f32 v154, v154, v6
    v_mul_f32 v155, v155, v6
    v_mul_f32 v156, v156, v6
    v_mul_f32 v157, v157, v6
    v_mul_f32 v158, v158, v6
    v_mul_f32 v159, v159, v6
    v_cvt_pk_bf16_f32 v80, v152, v153
    v_cvt_pk_bf16_f32 v81, v154, v155
    v_cvt_pk_bf16_f32 v82, v156, v157
    v_cvt_pk_bf16_f32 v83, v158, v159
    buffer_store_dwordx4 v[80:83], v2, s[40:43], s12 offen sc1
    s_cmp_ge_u32 s3, 8
    s_cbranch_scc1 k_fin
    s_mov_b64 exec, 1
    ds_add_u32 v14, v15 offset:28
    s_mov_b64 exec, -1
    s_setprio 0
    s_lshr_b32 s15, s57, 3
    s_lshl2_add_u32 s4, s56, s15
    s_mul_i32 s4, s4, 294912
    s_lshl_b32 s13, s85, 12
    s_add_u32 s4, s4, s13
    s_add_u32 s4, s4, 8503296
    s_add_u32 s5, s4, 4096
    s_add_u32 s6, s4, 147456
    s_add_u32 s7, s5, 147456
    v_lshrrev_b32 v9, 4, v0
    v_mul_u32_u24 v9, 768, v9
    v_add_u32 v9, v9, v2
    v_add_u32 v6, s13, v2
    s_mov_b32 s10, s13
    v_add_u32 v112, 2304, v9
    v_add_u32 v113, 1536, v9
    v_add_u32 v114, 768, v9
    s_sub_u32 s24, s4, 2304
    s_sub_u32 s25, s5, 2304
    s_sub_u32 s26, s6, 2304
    s_sub_u32 s27, s7, 2304
    s_movk_i32 s12, 0xf
    s_movk_i32 s61, 0x2000
    s_mov_b64 s[16:17], -1
    s_mov_b64 s[18:19], -1
    s_mov_b64 s[20:21], -1
    s_mov_b64 s[22:23], -1
    v_and_b32 v3, 7, v0
    v_lshlrev_b32 v3, 10, v3
    v_bfe_u32 v4, v0, 3, 1
    v_mul_u32_u24 v4, 147456, v4
    v_add_u32 v3, v3, v4
    s_mov_b32 s13, 0
    s_mov_b32 s62, 131072
lp_31:
    ds_read_b32 v7, v14 offset:24
    s_waitcnt lgkmcnt(0)
    v_cmp_gt_u32 vcc, 1, v7
    s_cbranch_vccz lpd_32
    s_sleep 4
    s_sub_u32 s62, s62, 1
    s_cmp_lg_u32 s62, 0
    s_cbranch_scc1 lp_31
lpd_32:
    s_mov_b32 s62, 131072
lp_33:
    ds_read_b32 v7, v14 offset:28
    s_waitcnt lgkmcnt(0)
    v_cmp_gt_u32 vcc, 8, v7
    s_cbranch_vccz lpd_34
    s_sleep 4
    s_sub_u32 s62, s62, 1
    s_cmp_lg_u32 s62, 0
    s_cbranch_scc1 lp_33
lpd_34:
a_or:
    s_bitcmp0_b32 s13, 0
    s_cbranch_scc1 a_ol0
    s_add_u32 m0, s10, 0
    s_mov_b64 exec, s[16:17]
    buffer_load_dwordx4 v112, s[40:43], s24 offen offset:0 sc1 lds
    buffer_load_dwordx4 v113, s[40:43], s24 offen offset:1024 sc1 lds
    buffer_load_dwordx4 v114, s[40:43], s24 offen offset:2048 sc1 lds
    buffer_load_dwordx4 v9, s[40:43], s24 offen offset:3072 sc1 lds
a_ol0:
    s_bitcmp0_b32 s13, 1
    s_cbranch_scc1 a_ol1
    s_add_u32 m0, s10, 4096
    s_mov_b64 exec, s[18:19]
    buffer_load_dwordx4 v112, s[40:43], s25 offen offset:0 sc1 lds
    buffer_load_dwordx4 v113, s[40:43], s25 offen offset:1024 sc1 lds
    buffer_load_dwordx4 v114, s[40:43], s25 offen offset:2048 sc1 lds
    buffer_load_dwordx4 v9, s[40:43], s25 offen offset:3072 sc1 lds
a_ol1:
    s_bitcmp0_b32 s13, 2
    s_cbranch_scc1 a_ol2
    s_add_u32 m0, s10, 32768
    s_mov_b64 exec, s[20:21]
    buffer_load_dwordx4 v112, s[40:43], s26 offen offset:0 sc1 lds
    buffer_load_dwordx4 v113, s[40:43], s26 offen offset:1024 sc1 lds
    buffer_load_dwordx4 v114, s[40:43], s26 offen offset:2048 sc1 lds
    buffer_load_dwordx4 v9, s[40:43], s26 offen offset:3072 sc1 lds
a_ol2:
    s_bitcmp0_b32 s13, 3
    s_cbranch_scc1 a_ol3
    s_add_u32 m0, s10, 36864
    s_mov_b64 exec, s[22:23]
    buffer_load_dwordx4 v112, s[40:43], s27 offen offset:0 sc1 lds
    buffer_load_dwordx4 v113, s[40:43], s27 offen offset:1024 sc1 lds
    buffer_load_dwordx4 v114, s[40:43], s27 offen offset:2048 sc1 lds
    buffer_load_dwordx4 v9, s[40:43], s27 offen offset:3072 sc1 lds
a_ol3:
    s_andn2_b32 s14, s12, s13
    s_cbranch_scc0 a_onp
    s_mov_b64 exec, 0xffff
    buffer_load_dword v4, v3, s[40:43], s4 offen sc1
a_onp:
    s_mov_b64 exec, -1
    s_sub_u32 s61, s61, 1
    s_cselect_b64 s[8:9], 0, -1
    s_waitcnt vmcnt(0)
    s_bitcmp0_b32 s13, 0
    s_cbranch_scc1 a_ob0
    ds_read2st64_b32 v[16:17], v6 offset0:0 offset1:4
    ds_read2st64_b32 v[18:19], v6 offset0:8 offset1:12
a_ob0:
    s_bitcmp0_b32 s13, 1
    s_cbranch_scc1 a_ob1
    ds_read2st64_b32 v[32:33], v6 offset0:16 offset1:20
    ds_read2st64_b32 v[34:35], v6 offset0:24 offset1:28
a_ob1:
    s_bitcmp0_b32 s13, 2
    s_cbranch_scc1 a_ob2
    ds_read2st64_b32 v[48:49], v6 offset0:128 offset1:132
    ds_read2st64_b32 v[50:51], v6 offset0:136 offset1:140
a_ob2:
    s_bitcmp0_b32 s13, 3
    s_cbranch_scc1 a_ob3
    ds_read2st64_b32 v[64:65], v6 offset0:144 offset1:148
    ds_read2st64_b32 v[66:67], v6 offset0:152 offset1:156
a_ob3:
    s_waitcnt lgkmcnt(0)
    s_bitcmp0_b32 s13, 0
    s_cbranch_scc1 a_oc0
    v_max3_u32 v7, v16, v17, v18
    v_max_u32 v7, v7, v19
    v_cmp_eq_u32 vcc, -1, v7
    s_and_b64 s[16:17], vcc, s[8:9]
    s_cbranch_scc1 a_oc0
    ds_write_b32 v13, v15 offset:96
    s_bitset0_b32 s12, 0
a_oc0:
    s_bitcmp0_b32 s13, 1
    s_cbranch_scc1 a_oc1
    v_max3_u32 v7, v32, v33, v34
    v_max_u32 v7, v7, v35
    v_cmp_eq_u32 vcc, -1, v7
    s_and_b64 s[18:19], vcc, s[8:9]
    s_cbranch_scc1 a_oc1
    ds_write_b32 v13, v15 offset:100
    s_bitset0_b32 s12, 1
a_oc1:
    s_bitcmp0_b32 s13, 2
    s_cbranch_scc1 a_oc2
    v_max3_u32 v7, v48, v49, v50
    v_max_u32 v7, v7, v51
    v_cmp_eq_u32 vcc, -1, v7
    s_and_b64 s[20:21], vcc, s[8:9]
    s_cbranch_scc1 a_oc2
    ds_write_b32 v13, v15 offset:128
    s_bitset0_b32 s12, 2
a_oc2:
    s_bitcmp0_b32 s13, 3
    s_cbranch_scc1 a_oc3
    v_max3_u32 v7, v64, v65, v66
    v_max_u32 v7, v7, v67
    v_cmp_eq_u32 vcc, -1, v7
    s_and_b64 s[22:23], vcc, s[8:9]
    s_cbranch_scc1 a_oc3
    ds_write_b32 v13, v15 offset:132
    s_bitset0_b32 s12, 3
a_oc3:
    s_cmp_eq_u32 s12, 0
    s_cbranch_scc1 a_odone
    v_cmp_ne_u32 s[14:15], -1, v4
    s_quadmask_b32 s14, s14
    s_or_b32 s13, s13, s14
    s_cmp_lt_u32 s61, 16
    s_cselect_b32 s13, s12, s13
    s_and_b32 s13, s13, s12
    s_cbranch_scc0 a_osl
    s_sleep 1
    s_branch a_or
a_osl:
    s_sleep 6
    s_branch a_or
a_odone:
k_fin:
k_end:
    s_endpgm
.section .rodata,"a"
.p2align 6
.amdhsa_kernel gated_mix__mha_block__dense_activation_squared_relu__prompt_kernel
  .amdhsa_next_free_vgpr 168
  .amdhsa_next_free_sgpr 102
  .amdhsa_accum_offset 168
  .amdhsa_group_segment_fixed_size 0
  .amdhsa_kernarg_size 96
  .amdhsa_user_sgpr_count 2
  .amdhsa_user_sgpr_kernarg_segment_ptr 1
  .amdhsa_system_sgpr_workgroup_id_x 1
.end_amdhsa_kernel
```
